```python
import torch

def _softmax(x, axis=-1):
    return torch.softmax(x, dim=axis)
def _gelu(x):
    return torch.nn.functional.gelu(x, approximate="tanh")
def _silu(x):
    return torch.nn.functional.silu(x)
def _sigmoid(x):
    return torch.sigmoid(x)
def _layernorm(x, axis=-1, eps=1e-5):
    m = x.mean(dim=axis, keepdim=True)
    v = x.var(dim=axis, keepdim=True, unbiased=False)
    return (x - m) / torch.sqrt(v + eps)
def _scatter_add(tgt, idx, src, axis=0):
    return tgt.clone().index_add_(axis, idx, src)
def _segment_sum(src, seg, n):
    out = torch.zeros((n,) + src.shape[1:], dtype=src.dtype)
    return out.index_add_(0, seg, src)
def _pad(x, pw):
    flat = tuple(v for pair in reversed(pw) for v in pair)
    return torch.nn.functional.pad(x, flat)

kernel_name = 'standalone__ssm_conv_s4d__prompt'

def setup_inputs():

    _w = (lambda a: (lambda t: t.to(torch.bfloat16) if t.is_floating_point() else t)(torch.as_tensor(a)))
    Bsz, L, D, N = 1, 2048, 512, 128
    return {
        "u": _w((lambda *s: torch.randn(*s, dtype=torch.bfloat16) * 0.05)(Bsz, L, D)),
        "log_A_real": _w((lambda *s: torch.randn(*s, dtype=torch.bfloat16) * 6.4)(D, N) * 0.5),
        "A_imag": _w((lambda *s: torch.randn(*s, dtype=torch.bfloat16) * 0.05)(D, N) * 3.14),
        "C_real": _w((lambda *s: torch.randn(*s, dtype=torch.bfloat16) * 0.05)(D, N) / N ** 0.5),
        "C_imag": _w((lambda *s: torch.randn(*s, dtype=torch.bfloat16) * 0.05)(D, N) / N ** 0.5),
        "log_dt": _w((lambda *s: torch.randn(*s, dtype=torch.bfloat16) * 0.05)(D) * 0.5 - 4.0),
        "D_skip": _w((lambda *s: torch.randn(*s, dtype=torch.bfloat16) * 0.05)(D)),
    }

def reference(u, log_A_real, A_imag, C_real, C_imag, log_dt, D_skip):
    L = u.shape[1]
    dt = torch.exp(log_dt)
    A = -torch.exp(log_A_real) + 1j * A_imag
    C = (C_real + 1j * C_imag) * dt[:, None]
    pos = (lambda x, dt: x.to(dt))(torch.arange(L), log_dt.dtype)
    P = torch.exp((A * dt[:, None])[:, :, None] * pos[None, None, :])
    K = 2.0 * torch.einsum("dn,dnl->dl", C, P).real
    L2 = 2 * L
    u_t = (lambda x, *d: x.permute(*d))(u, 0, 2, 1)
    Kf = (lambda x, *a, **k: torch.fft.rfft(x.float(), *a, **k))(K, L2)
    Uf = (lambda x, *a, **k: torch.fft.rfft(x.float(), *a, **k))(u_t, L2)
    y = (lambda x, *a, **k: torch.fft.irfft(x, *a, **k).to(torch.bfloat16))(Uf * Kf[None, :, :], L2)[:, :, :L]
    y = (lambda x, *d: x.permute(*d))(y, 0, 2, 1)
    return y + u * D_skip[None, None, :]
```

```asm
; @launch grid=(256,1,1) block=(512,1,1) lds=99392
.amdgcn_target "amdgcn-amd-amdhsa--gfx950"
.text
.globl standalone__ssm_conv_s4d__prompt_kernel
.p2align 8
.type standalone__ssm_conv_s4d__prompt_kernel,@function
standalone__ssm_conv_s4d__prompt_kernel:
    s_load_dwordx16 s[64:79], s[0:1], 0
    s_load_dwordx2 s[20:21], s[0:1], 72
    s_cmp_ge_u32 s2, 256
    s_cbranch_scc1 L_end

    s_getpc_b64 s[44:45]
L_pc:
    v_min_u32 v100, (L_end-L_pc)/64, v0
    v_lshlrev_b32 v100, 6, v100
    v_mov_b32 v101, s45
    v_add_co_u32 v100, vcc, s44, v100
    v_addc_co_u32 v101, vcc, 0, v101, vcc
    global_load_dword v102, v[100:101], off

    v_lshrrev_b32 v2, 6, v0
    v_and_b32 v3, 63, v0
    s_and_b32 s28, s2, 7
    s_lshr_b32 s29, s2, 3
    v_readfirstlane_b32 s24, v2
    s_lshl_b32 s31, s28, 7
    s_lshl_b32 s30, s29, 16
    s_add_u32 s30, s30, s31
    s_and_b32 s26, s24, 3
    s_lshr_b32 s27, s26, 1
    s_and_b32 s33, s26, 1
    s_lshl_b32 s34, s29, 2
    s_add_u32 s35, s34, s31
    s_add_u32 s34, s35, s26
    s_lshl_b32 s34, s34, 7
    v_lshl_add_u32 v1, v3, 1, s34
    v_mov_b32 v16, 0
    v_mov_b32 v17, 0
    s_lshl1_add_u32 s35, s27, s35
    v_mov_b32 v20, 0
    v_mov_b32 v21, s35
    s_cmp_ge_u32 s24, 4
    s_cbranch_scc1 L_h1
    v_mov_b32 v18, 0
    v_mov_b32 v19, 0
    s_waitcnt lgkmcnt(0)
    global_load_short_d16_hi v20, v21, s[74:75]
    global_load_short_d16_hi v16, v1, s[66:67]
    global_load_short_d16_hi v17, v1, s[68:69]
    global_load_short_d16_hi v18, v1, s[70:71]
    global_load_short_d16_hi v19, v1, s[72:73]

    v_lshrrev_b32 v236, 2, v3
    v_lshlrev_b32 v236, 10, v236
    s_lshl_b32 s44, s26, 14
    s_add_u32 s44, s44, s30
    v_add_u32 v236, s44, v236
    global_load_dword v237, v236, s[78:79] sc1

    s_branch L_cm2
L_h1:
    s_setprio 2
    v_lshrrev_b32 v96, 2, v3
    v_and_b32 v97, 3, v3
    s_lshl_b32 s44, s27, 13
    s_lshl_b32 s45, s33, 6
    s_add_u32 s44, s44, s45
    v_lshrrev_b32 v6, 4, v3
    v_lshlrev_b32 v6, 14, v6
    v_and_b32 v7, 3, v96
    v_lshl_add_u32 v6, v7, 11, v6
    v_lshl_add_u32 v6, v97, 4, v6
    v_add_u32 v6, s44, v6
    s_add_u32 s45, s45, s31
    s_mov_b32 s10, 0x200000
    s_mov_b32 s11, 0x20000
    v_lshl_add_u32 v7, v97, 4, s45
    s_waitcnt lgkmcnt(0)
    s_mov_b32 s8, s64
    s_mov_b32 s9, s65
    buffer_load_dwordx4 v[8:11], v6, s[8:11], s30 offen
    buffer_load_dwordx4 v[12:15], v6, s[8:11], s30 offen offset:1024
    global_load_short_d16_hi v16, v1, s[66:67]
    global_load_short_d16_hi v17, v1, s[68:69]
    global_load_short_d16_hi v20, v21, s[74:75]
    global_load_dwordx4 v[60:63], v7, s[76:77]
    s_lshl_b32 s32, s28, 13
    s_add_u32 s32, s32, 1048576
    v_lshl_add_u32 v59, v3, 4, s32
    v_mov_b32 v58, s32
    global_load_dwordx2 v[54:55], v58, s[20:21] offset:4088
    global_load_dword v103, v59, s[20:21] sc1
L_cm2:
    s_lshl_b32 s32, s28, 13
    s_add_u32 s32, s32, 1048576
    s_add_u32 s16, s20, s32
    s_addc_u32 s17, s21, 0
    s_mov_b32 s12, s78
    s_mov_b32 s13, s79
    s_mov_b32 s78, s24
    s_mov_b32 s18, 8192
    s_mov_b32 s19, 0x20000
    s_mov_b32 s14, 0x200000
    s_mov_b32 s15, 0x20000
    s_getreg_b32 s25, hwreg(HW_REG_XCC_ID, 0, 4)
    s_mul_i32 s38, s27, 31008
    s_lshl_b32 s39, s33, 8
    s_add_u32 s38, s38, s39
    s_mov_b32 m0, s38
    s_lshl_b32 s39, s29, 2
    s_add_u32 s39, s39, s26
    s_lshl_b32 s39, s39, 3
    s_bfe_u32 s58, s29, 0x20002
    s_lshl_b32 s58, s58, 14
    s_and_b32 s59, s29, 3
    s_lshl_b32 s59, s59, 11
    s_add_u32 s58, s58, s59
    s_lshr_b32 s59, s29, 4
    s_lshl_b32 s59, s59, 6
    s_add_u32 s58, s58, s59
    s_add_u32 s58, s58, s31
    s_mov_b32 s50, 0x3fb8aa00
    s_mov_b32 s51, 0x36a407db
    s_cmp_ge_u32 s24, 4
    s_cbranch_scc1 L_helper

    v_and_b32 v4, 15, v3
    v_lshrrev_b32 v5, 4, v3
    s_mul_i32 s41, s27, 4736
    s_add_u32 s41, s41, 71488
    s_mul_i32 s42, s27, 4608
    s_add_u32 s42, s42, 62272
    s_mul_i32 s43, s27, 31008
    v_mul_u32_u24 v6, 544, v4
    v_lshl_add_u32 v6, v5, 4, v6
    v_add_u32 v6, s43, v6

    s_cmp_eq_u32 s33, 0
    s_cbranch_scc0 L_addrO
    v_lshlrev_b32 v12, 4, v4
    v_lshrrev_b32 v25, 1, v5
    v_lshl_add_u32 v12, v25, 8, v12
    v_and_b32 v25, 1, v5
    v_lshl_add_u32 v12, v25, 3, v12
    s_add_u32 s44, s41, 2106
    v_sub_u32 v12, s44, v12
    v_lshlrev_b32 v13, 1, v4
    v_lshl_add_u32 v13, v5, 7, v13
    s_add_u32 s44, s41, 4564
    v_sub_u32 v13, s44, v13
    v_and_b32 v14, 7, v3
    v_lshlrev_b32 v14, 1, v14
    v_lshrrev_b32 v25, 3, v3
    v_mul_u32_u24 v25, 2246, v25
    s_add_u32 s44, s41, 56
    v_add3_u32 v14, v14, v25, s44
    s_branch L_addrD
L_addrO:
    v_max_u32 v25, 1, v5
    v_add_u32 v25, v25, v5
    v_lshlrev_b32 v25, 8, v25
    v_lshl_add_u32 v25, v4, 4, v25
    s_add_u32 s44, s41, 1844
    v_sub_u32 v12, s44, v25
    v_add_u32 v13, 2244, v12
L_addrD:

    v_lshlrev_b32 v7, 5, v4
    v_lshl_add_u32 v7, v5, 4, v7
    v_add_u32 v7, s42, v7
    v_and_b32 v24, 1, v4
    v_mul_u32_u24 v8, 2246, v24
    v_lshl_add_u32 v8, v5, 4, v8
    v_lshlrev_b32 v25, 1, v4
    v_sub_u32 v8, v8, v25
    s_lshl_b32 s44, s33, 6
    s_sub_u32 s44, s41, s44
    s_add_u32 s44, s44, 1184
    v_add_u32 v8, s44, v8

    v_add_u32 v9, -1024, v8
    v_add_u32 v10, -128, v9
    v_lshlrev_b32 v11, 4, v5
    v_lshlrev_b32 v25, 2, v4
    v_sub_u32 v11, v11, v25
    s_add_u32 s44, s41, 4464
    v_add_u32 v11, s44, v11
    v_lshlrev_b32 v25, 3, v5
    v_sub_u32 v25, v25, v4
    v_add_u32 v26, 16, v25
    v_add_u32 v27, 15, v25
    v_min_u32 v26, 31, v26
    v_min_u32 v27, 31, v27
    s_mov_b32 s44, 535822336
    s_mov_b32 s45, 133169152
    v_lshrrev_b32 v26, v26, s44
    v_lshrrev_b32 v27, v27, s45
    s_movk_i32 s46, 0x3f80

    v_bfe_u32 v224, v26, 0, 2
    v_lshl_or_b32 v224, v224, 15, v224
    v_and_b32 v224, 0x10001, v224
    v_mul_u32_u24 v224, s46, v224
    v_bfe_u32 v225, v26, 2, 2
    v_lshl_or_b32 v225, v225, 15, v225
    v_and_b32 v225, 0x10001, v225
    v_mul_u32_u24 v225, s46, v225
    v_bfe_u32 v226, v26, 4, 2
    v_lshl_or_b32 v226, v226, 15, v226
    v_and_b32 v226, 0x10001, v226
    v_mul_u32_u24 v226, s46, v226
    v_bfe_u32 v227, v26, 6, 2
    v_lshl_or_b32 v227, v227, 15, v227
    v_and_b32 v227, 0x10001, v227
    v_mul_u32_u24 v227, s46, v227
    v_bfe_u32 v228, v27, 0, 2
    v_lshl_or_b32 v228, v228, 15, v228
    v_and_b32 v228, 0x10001, v228
    v_mul_u32_u24 v228, s46, v228
    v_bfe_u32 v229, v27, 2, 2
    v_lshl_or_b32 v229, v229, 15, v229
    v_and_b32 v229, 0x10001, v229
    v_mul_u32_u24 v229, s46, v229
    v_bfe_u32 v230, v27, 4, 2
    v_lshl_or_b32 v230, v230, 15, v230
    v_and_b32 v230, 0x10001, v230
    v_mul_u32_u24 v230, s46, v230
    v_bfe_u32 v231, v27, 6, 2
    v_lshl_or_b32 v231, v231, 15, v231
    v_and_b32 v231, 0x10001, v231
    v_mul_u32_u24 v231, s46, v231
    v_lshrrev_b32 v15, 2, v4
    v_and_b32 v25, 1, v5
    v_lshl_add_u32 v15, v25, 2, v15
    v_lshlrev_b32 v15, 16, v15
    v_and_b32 v25, 3, v4
    v_lshrrev_b32 v26, 1, v5
    v_lshl_add_u32 v15, v25, 4, v15
    v_lshl_add_u32 v15, v26, 13, v15
    v_lshl_add_u32 v25, v26, 2, v25
    s_lshl_b32 s44, s27, 10
    s_add_u32 s47, s58, s44
    s_lshl_b32 s44, s33, 20
    s_add_u32 s47, s47, s44
    s_add_u32 s48, s47, 0x80000
    s_lshl_b32 s44, s26, 12
    v_lshl_add_u32 v232, v3, 4, s44
    v_xor_b32 v233, 0x1000, v232
    v_lshlrev_b32 v235, 2, v4
    s_lshl_b32 s44, s26, 2
    v_mov_b32 v239, s44
    s_xor_b32 s44, s26, 1
    s_lshl_b32 s55, 0x100, s44
    s_or_b32 s55, s55, 0xf000
    v_lshrrev_b32 v238, 16, v15
    v_lshlrev_b32 v238, 8, v238
    v_lshl_add_u32 v238, v25, 4, v238
    s_lshl_b32 s44, s33, 12
    s_lshl_b32 s45, s27, 7
    s_add_u32 s44, s44, s45
    s_add_u32 s44, s44, 91200
    v_add_u32 v238, s44, v238

    s_waitcnt vmcnt(1)
    v_mul_f32 v24, s50, v20
    v_mul_f32 v25, s51, v20
    v_exp_f32 v24, v24
    v_mul_f32 v26, s50, v16
    v_mul_f32 v27, s51, v16
    v_fma_f32 v24, v24, v25, v24
    v_exp_f32 v26, v26
    v_cvt_pk_bf16_f32 v24, v24, v24
    v_fma_f32 v26, v26, v27, v26
    v_lshlrev_b32 v20, 16, v24
    v_cvt_pk_bf16_f32 v26, v26, v26
    v_mul_f32 v22, v17, v20
    v_lshlrev_b32 v21, 16, v26
    v_mul_f32 v22, 0x3e22f983, v22
    v_mul_f32 v21, v21, v20
    v_fract_f32 v31, v22
    v_mul_f32 v21, 0xbfb8aa3b, v21
    v_cos_f32 v28, v31
    v_exp_f32 v30, v21
    v_sin_f32 v29, v31
    v_add_f32 v20, v20, v20
    v_mul_f32 v35, 0x43000000, v22
    v_pk_mul_f32 v[28:29], v[28:29], v[30:31] op_sel_hi:[1,0]
    v_pk_mul_f32 v[40:41], v[18:19], v[20:21] op_sel_hi:[1,0]
    v_pk_mul_f32 v[132:133], v[28:29], v[28:29] op_sel_hi:[1,0]
    v_pk_mul_f32 v[134:135], v[40:41], v[28:29] op_sel_hi:[1,0]
    v_mul_f32 v34, 0x43000000, v21
    v_fract_f32 v35, v35
    v_pk_fma_f32 v[36:37], v[28:29], v[28:29], v[132:133] op_sel:[1,1,0] op_sel_hi:[0,1,1] neg_lo:[0,1,0]
    v_pk_fma_f32 v[42:43], v[40:41], v[28:29], v[134:135] op_sel:[1,1,0] op_sel_hi:[0,1,1] neg_lo:[0,1,0]
    v_exp_f32 v34, v34
    v_cos_f32 v32, v35
    v_sin_f32 v33, v35
    v_pk_mul_f32 v[136:137], v[40:41], v[36:37] op_sel_hi:[1,0]
    v_pk_mul_f32 v[138:139], v[42:43], v[36:37] op_sel_hi:[1,0]
    v_pk_mul_f32 v[32:33], v[32:33], v[34:35] op_sel_hi:[1,0]
    v_pk_fma_f32 v[44:45], v[40:41], v[36:37], v[136:137] op_sel:[1,1,0] op_sel_hi:[0,1,1] neg_lo:[0,1,0]
    v_pk_fma_f32 v[46:47], v[42:43], v[36:37], v[138:139] op_sel:[1,1,0] op_sel_hi:[0,1,1] neg_lo:[0,1,0]
    v_pk_mul_f32 v[140:141], v[44:45], v[36:37] op_sel_hi:[1,0]
    v_pk_mul_f32 v[142:143], v[46:47], v[36:37] op_sel_hi:[1,0]
    v_pk_mul_f32 v[132:133], v[32:33], v[32:33] op_sel_hi:[1,0]
    v_pk_mul_f32 v[134:135], v[40:41], v[32:33] op_sel_hi:[1,0]
    v_pk_fma_f32 v[48:49], v[44:45], v[36:37], v[140:141] op_sel:[1,1,0] op_sel_hi:[0,1,1] neg_lo:[0,1,0]
    v_pk_fma_f32 v[50:51], v[46:47], v[36:37], v[142:143] op_sel:[1,1,0] op_sel_hi:[0,1,1] neg_lo:[0,1,0]
    v_pk_fma_f32 v[38:39], v[32:33], v[32:33], v[132:133] op_sel:[1,1,0] op_sel_hi:[0,1,1] neg_lo:[0,1,0]
    v_pk_fma_f32 v[56:57], v[40:41], v[32:33], v[134:135] op_sel:[1,1,0] op_sel_hi:[0,1,1] neg_lo:[0,1,0]
    v_pk_mul_f32 v[144:145], v[48:49], v[36:37] op_sel_hi:[1,0]
    v_pk_mul_f32 v[130:131], v[50:51], v[36:37] op_sel_hi:[1,0]
    v_pk_mul_f32 v[138:139], v[44:45], v[32:33] op_sel_hi:[1,0]
    v_pk_mul_f32 v[142:143], v[48:49], v[32:33] op_sel_hi:[1,0]
    v_pk_mul_f32 v[134:135], v[40:41], v[38:39] op_sel_hi:[1,0]
    v_pk_fma_f32 v[52:53], v[48:49], v[36:37], v[144:145] op_sel:[1,1,0] op_sel_hi:[0,1,1] neg_lo:[0,1,0]
    v_pk_fma_f32 v[54:55], v[50:51], v[36:37], v[130:131] op_sel:[1,1,0] op_sel_hi:[0,1,1] neg_lo:[0,1,0]
    v_pk_fma_f32 v[60:61], v[44:45], v[32:33], v[138:139] op_sel:[1,1,0] op_sel_hi:[0,1,1] neg_lo:[0,1,0]
    v_pk_fma_f32 v[64:65], v[48:49], v[32:33], v[142:143] op_sel:[1,1,0] op_sel_hi:[0,1,1] neg_lo:[0,1,0]
    v_pk_fma_f32 v[72:73], v[40:41], v[38:39], v[134:135] op_sel:[1,1,0] op_sel_hi:[0,1,1] neg_lo:[0,1,0]
    v_pk_mul_f32 v[136:137], v[42:43], v[32:33] op_sel_hi:[1,0]
    v_pk_mul_f32 v[130:131], v[52:53], v[32:33] op_sel_hi:[1,0]
    v_pk_mul_f32 v[138:139], v[48:49], v[38:39] op_sel_hi:[1,0]
    v_pk_mul_f32 v[142:143], v[56:57], v[38:39] op_sel_hi:[1,0]
    v_pk_mul_f32 v[134:135], v[72:73], v[38:39] op_sel_hi:[1,0]
    v_pk_fma_f32 v[58:59], v[42:43], v[32:33], v[136:137] op_sel:[1,1,0] op_sel_hi:[0,1,1] neg_lo:[0,1,0]
    v_pk_fma_f32 v[68:69], v[52:53], v[32:33], v[130:131] op_sel:[1,1,0] op_sel_hi:[0,1,1] neg_lo:[0,1,0]
    v_pk_fma_f32 v[76:77], v[48:49], v[38:39], v[138:139] op_sel:[1,1,0] op_sel_hi:[0,1,1] neg_lo:[0,1,0]
    v_pk_fma_f32 v[80:81], v[56:57], v[38:39], v[142:143] op_sel:[1,1,0] op_sel_hi:[0,1,1] neg_lo:[0,1,0]
    v_pk_fma_f32 v[88:89], v[72:73], v[38:39], v[134:135] op_sel:[1,1,0] op_sel_hi:[0,1,1] neg_lo:[0,1,0]
    v_pk_mul_f32 v[140:141], v[46:47], v[32:33] op_sel_hi:[1,0]
    v_pk_mul_f32 v[136:137], v[44:45], v[38:39] op_sel_hi:[1,0]
    v_pk_mul_f32 v[130:131], v[64:65], v[38:39] op_sel_hi:[1,0]
    v_pk_mul_f32 v[138:139], v[80:81], v[38:39] op_sel_hi:[1,0]
    v_pk_mul_f32 v[142:143], v[88:89], v[38:39] op_sel_hi:[1,0]
    v_pk_fma_f32 v[62:63], v[46:47], v[32:33], v[140:141] op_sel:[1,1,0] op_sel_hi:[0,1,1] neg_lo:[0,1,0]
    v_pk_fma_f32 v[74:75], v[44:45], v[38:39], v[136:137] op_sel:[1,1,0] op_sel_hi:[0,1,1] neg_lo:[0,1,0]
    v_pk_fma_f32 v[84:85], v[64:65], v[38:39], v[130:131] op_sel:[1,1,0] op_sel_hi:[0,1,1] neg_lo:[0,1,0]
    v_pk_fma_f32 v[92:93], v[80:81], v[38:39], v[138:139] op_sel:[1,1,0] op_sel_hi:[0,1,1] neg_lo:[0,1,0]
    v_pk_fma_f32 v[96:97], v[88:89], v[38:39], v[142:143] op_sel:[1,1,0] op_sel_hi:[0,1,1] neg_lo:[0,1,0]
    v_pk_mul_f32 v[144:145], v[50:51], v[32:33] op_sel_hi:[1,0]
    v_pk_mul_f32 v[140:141], v[52:53], v[38:39] op_sel_hi:[1,0]
    v_pk_mul_f32 v[136:137], v[76:77], v[38:39] op_sel_hi:[1,0]
    v_pk_mul_f32 v[130:131], v[92:93], v[38:39] op_sel_hi:[1,0]
    v_pk_mul_f32 v[134:135], v[96:97], v[38:39] op_sel_hi:[1,0]
    v_cvt_pk_bf16_f32 v150, v40, -v41
    v_pk_fma_f32 v[66:67], v[50:51], v[32:33], v[144:145] op_sel:[1,1,0] op_sel_hi:[0,1,1] neg_lo:[0,1,0]
    v_pk_fma_f32 v[78:79], v[52:53], v[38:39], v[140:141] op_sel:[1,1,0] op_sel_hi:[0,1,1] neg_lo:[0,1,0]
    v_pk_fma_f32 v[90:91], v[76:77], v[38:39], v[136:137] op_sel:[1,1,0] op_sel_hi:[0,1,1] neg_lo:[0,1,0]
    v_pk_fma_f32 v[100:101], v[92:93], v[38:39], v[130:131] op_sel:[1,1,0] op_sel_hi:[0,1,1] neg_lo:[0,1,0]
    v_pk_fma_f32 v[104:105], v[96:97], v[38:39], v[134:135] op_sel:[1,1,0] op_sel_hi:[0,1,1] neg_lo:[0,1,0]
    ds_write_addtid_b32 v150 offset:0
    v_pk_mul_f32 v[132:133], v[54:55], v[32:33] op_sel_hi:[1,0]
    v_pk_mul_f32 v[144:145], v[60:61], v[38:39] op_sel_hi:[1,0]
    v_pk_mul_f32 v[140:141], v[84:85], v[38:39] op_sel_hi:[1,0]
    v_pk_mul_f32 v[136:137], v[100:101], v[38:39] op_sel_hi:[1,0]
    v_pk_mul_f32 v[138:139], v[104:105], v[38:39] op_sel_hi:[1,0]
    v_cvt_pk_bf16_f32 v151, v42, -v43
    v_cvt_pk_bf16_f32 v152, v44, -v45
    v_cvt_pk_bf16_f32 v153, v46, -v47
    v_cvt_pk_bf16_f32 v154, v48, -v49
    v_cvt_pk_bf16_f32 v155, v50, -v51
    v_cvt_pk_bf16_f32 v156, v52, -v53
    v_cvt_pk_bf16_f32 v157, v54, -v55
    v_cvt_pk_bf16_f32 v150, v56, -v57
    v_pk_fma_f32 v[70:71], v[54:55], v[32:33], v[132:133] op_sel:[1,1,0] op_sel_hi:[0,1,1] neg_lo:[0,1,0]
    v_pk_fma_f32 v[82:83], v[60:61], v[38:39], v[144:145] op_sel:[1,1,0] op_sel_hi:[0,1,1] neg_lo:[0,1,0]
    v_pk_fma_f32 v[94:95], v[84:85], v[38:39], v[140:141] op_sel:[1,1,0] op_sel_hi:[0,1,1] neg_lo:[0,1,0]
    v_pk_fma_f32 v[106:107], v[100:101], v[38:39], v[136:137] op_sel:[1,1,0] op_sel_hi:[0,1,1] neg_lo:[0,1,0]
    v_pk_fma_f32 v[108:109], v[104:105], v[38:39], v[138:139] op_sel:[1,1,0] op_sel_hi:[0,1,1] neg_lo:[0,1,0]
    ds_write_addtid_b32 v151 offset:544
    ds_write_addtid_b32 v152 offset:1088
    ds_write_addtid_b32 v153 offset:1632
    ds_write_addtid_b32 v154 offset:2176
    ds_write_addtid_b32 v155 offset:2720
    ds_write_addtid_b32 v156 offset:3264
    ds_write_addtid_b32 v157 offset:3808
    ds_write_addtid_b32 v150 offset:4352
    v_pk_mul_f32 v[132:133], v[68:69], v[38:39] op_sel_hi:[1,0]
    v_pk_mul_f32 v[144:145], v[90:91], v[38:39] op_sel_hi:[1,0]
    v_pk_mul_f32 v[140:141], v[106:107], v[38:39] op_sel_hi:[1,0]
    v_pk_mul_f32 v[142:143], v[108:109], v[38:39] op_sel_hi:[1,0]
    v_cvt_pk_bf16_f32 v151, v58, -v59
    v_cvt_pk_bf16_f32 v152, v60, -v61
    v_cvt_pk_bf16_f32 v153, v62, -v63
    v_cvt_pk_bf16_f32 v154, v64, -v65
    v_cvt_pk_bf16_f32 v155, v66, -v67
    v_cvt_pk_bf16_f32 v156, v68, -v69
    v_cvt_pk_bf16_f32 v157, v70, -v71
    v_cvt_pk_bf16_f32 v150, v72, -v73
    v_pk_fma_f32 v[86:87], v[68:69], v[38:39], v[132:133] op_sel:[1,1,0] op_sel_hi:[0,1,1] neg_lo:[0,1,0]
    v_pk_fma_f32 v[98:99], v[90:91], v[38:39], v[144:145] op_sel:[1,1,0] op_sel_hi:[0,1,1] neg_lo:[0,1,0]
    v_pk_fma_f32 v[110:111], v[106:107], v[38:39], v[140:141] op_sel:[1,1,0] op_sel_hi:[0,1,1] neg_lo:[0,1,0]
    v_pk_fma_f32 v[112:113], v[108:109], v[38:39], v[142:143] op_sel:[1,1,0] op_sel_hi:[0,1,1] neg_lo:[0,1,0]
    ds_write_addtid_b32 v151 offset:4896
    ds_write_addtid_b32 v152 offset:5440
    ds_write_addtid_b32 v153 offset:5984
    ds_write_addtid_b32 v154 offset:6528
    ds_write_addtid_b32 v155 offset:7072
    ds_write_addtid_b32 v156 offset:7616
    ds_write_addtid_b32 v157 offset:8160
    ds_write_addtid_b32 v150 offset:8704
    v_pk_mul_f32 v[132:133], v[94:95], v[38:39] op_sel_hi:[1,0]
    v_pk_mul_f32 v[144:145], v[110:111], v[38:39] op_sel_hi:[1,0]
    v_pk_mul_f32 v[130:131], v[112:113], v[38:39] op_sel_hi:[1,0]
    v_cvt_pk_bf16_f32 v151, v74, -v75
    v_cvt_pk_bf16_f32 v152, v76, -v77
    v_cvt_pk_bf16_f32 v153, v78, -v79
    v_cvt_pk_bf16_f32 v154, v80, -v81
    v_cvt_pk_bf16_f32 v155, v82, -v83
    v_cvt_pk_bf16_f32 v156, v84, -v85
    v_cvt_pk_bf16_f32 v157, v86, -v87
    v_cvt_pk_bf16_f32 v150, v88, -v89
    v_pk_fma_f32 v[102:103], v[94:95], v[38:39], v[132:133] op_sel:[1,1,0] op_sel_hi:[0,1,1] neg_lo:[0,1,0]
    v_pk_fma_f32 v[114:115], v[110:111], v[38:39], v[144:145] op_sel:[1,1,0] op_sel_hi:[0,1,1] neg_lo:[0,1,0]
    v_pk_fma_f32 v[116:117], v[112:113], v[38:39], v[130:131] op_sel:[1,1,0] op_sel_hi:[0,1,1] neg_lo:[0,1,0]
    ds_write_addtid_b32 v151 offset:9248
    ds_write_addtid_b32 v152 offset:9792
    ds_write_addtid_b32 v153 offset:10336
    ds_write_addtid_b32 v154 offset:10880
    ds_write_addtid_b32 v155 offset:11424
    ds_write_addtid_b32 v156 offset:11968
    ds_write_addtid_b32 v157 offset:12512
    ds_write_addtid_b32 v150 offset:13056
    v_pk_mul_f32 v[132:133], v[114:115], v[38:39] op_sel_hi:[1,0]
    v_pk_mul_f32 v[134:135], v[116:117], v[38:39] op_sel_hi:[1,0]
    v_cvt_pk_bf16_f32 v151, v90, -v91
    v_cvt_pk_bf16_f32 v152, v92, -v93
    v_cvt_pk_bf16_f32 v153, v94, -v95
    v_cvt_pk_bf16_f32 v154, v96, -v97
    v_cvt_pk_bf16_f32 v155, v98, -v99
    v_cvt_pk_bf16_f32 v156, v100, -v101
    v_cvt_pk_bf16_f32 v157, v102, -v103
    v_cvt_pk_bf16_f32 v150, v104, -v105
    v_pk_fma_f32 v[118:119], v[114:115], v[38:39], v[132:133] op_sel:[1,1,0] op_sel_hi:[0,1,1] neg_lo:[0,1,0]
    v_pk_fma_f32 v[120:121], v[116:117], v[38:39], v[134:135] op_sel:[1,1,0] op_sel_hi:[0,1,1] neg_lo:[0,1,0]
    ds_write_addtid_b32 v151 offset:13600
    ds_write_addtid_b32 v152 offset:14144
    ds_write_addtid_b32 v153 offset:14688
    ds_write_addtid_b32 v154 offset:15232
    ds_write_addtid_b32 v155 offset:15776
    ds_write_addtid_b32 v156 offset:16320
    ds_write_addtid_b32 v157 offset:16864
    ds_write_addtid_b32 v150 offset:17408
    v_cvt_pk_bf16_f32 v151, v106, -v107
    v_cvt_pk_bf16_f32 v152, v108, -v109
    v_cvt_pk_bf16_f32 v153, v110, -v111
    v_cvt_pk_bf16_f32 v154, v112, -v113
    v_cvt_pk_bf16_f32 v155, v114, -v115
    v_cvt_pk_bf16_f32 v156, v116, -v117
    v_cvt_pk_bf16_f32 v157, v118, -v119
    v_cvt_pk_bf16_f32 v150, v120, -v121
    ds_write_addtid_b32 v151 offset:17952
    ds_write_addtid_b32 v152 offset:18496
    ds_write_addtid_b32 v153 offset:19040
    ds_write_addtid_b32 v154 offset:19584
    ds_write_addtid_b32 v155 offset:20128
    ds_write_addtid_b32 v156 offset:20672
    ds_write_addtid_b32 v157 offset:21216
    ds_write_addtid_b32 v150 offset:21760
    s_waitcnt lgkmcnt(0)
    s_barrier
    s_cmp_eq_u32 s33, 0
    s_cbranch_scc0 L_kO
    ds_read_b128 v[64:67], v6 offset:22304
    ds_read_b128 v[96:99], v6 offset:0
    ds_read_b128 v[128:131], v6 offset:17408
    ds_read_b128 v[68:71], v6 offset:22368
    ds_read_b128 v[100:103], v6 offset:64
    ds_read_b128 v[132:135], v6 offset:17472
    ds_read_b128 v[72:75], v6 offset:22432
    ds_read_b128 v[104:107], v6 offset:128
    ds_read_b128 v[136:139], v6 offset:17536
    ds_read_b128 v[76:79], v6 offset:22496
    ds_read_b128 v[108:111], v6 offset:192
    ds_read_b128 v[140:143], v6 offset:17600
    s_waitcnt lgkmcnt(10)
    v_mfma_f32_16x16x32_bf16 v[40:43], v[96:99], v[64:67], 0
    s_waitcnt lgkmcnt(9)
    v_mfma_f32_16x16x32_bf16 v[44:47], v[128:131], v[64:67], 0
    ds_read_b128 v[80:83], v6 offset:22560
    ds_read_b128 v[112:115], v6 offset:256
    ds_read_b128 v[144:147], v6 offset:17664
    s_waitcnt lgkmcnt(10)
    v_mfma_f32_16x16x32_bf16 v[40:43], v[100:103], v[68:71], v[40:43]
    s_waitcnt lgkmcnt(9)
    v_mfma_f32_16x16x32_bf16 v[44:47], v[132:135], v[68:71], v[44:47]
    ds_read_b128 v[84:87], v6 offset:22624
    ds_read_b128 v[116:119], v6 offset:320
    ds_read_b128 v[148:151], v6 offset:17728
    s_waitcnt lgkmcnt(10)
    v_mfma_f32_16x16x32_bf16 v[40:43], v[104:107], v[72:75], v[40:43]
    s_waitcnt lgkmcnt(9)
    v_mfma_f32_16x16x32_bf16 v[44:47], v[136:139], v[72:75], v[44:47]
    ds_read_b128 v[88:91], v6 offset:22688
    ds_read_b128 v[120:123], v6 offset:384
    ds_read_b128 v[152:155], v6 offset:17792
    s_waitcnt lgkmcnt(10)
    v_mfma_f32_16x16x32_bf16 v[40:43], v[108:111], v[76:79], v[40:43]
    s_waitcnt lgkmcnt(9)
    v_mfma_f32_16x16x32_bf16 v[44:47], v[140:143], v[76:79], v[44:47]
    ds_read_b128 v[92:95], v6 offset:22752
    ds_read_b128 v[124:127], v6 offset:448
    ds_read_b128 v[156:159], v6 offset:17856
    s_waitcnt lgkmcnt(10)
    v_mfma_f32_16x16x32_bf16 v[40:43], v[112:115], v[80:83], v[40:43]
    s_waitcnt lgkmcnt(9)
    v_mfma_f32_16x16x32_bf16 v[44:47], v[144:147], v[80:83], v[44:47]
    s_waitcnt lgkmcnt(7)
    v_mfma_f32_16x16x32_bf16 v[40:43], v[116:119], v[84:87], v[40:43]
    s_waitcnt lgkmcnt(6)
    v_mfma_f32_16x16x32_bf16 v[44:47], v[148:151], v[84:87], v[44:47]
    s_waitcnt lgkmcnt(4)
    v_mfma_f32_16x16x32_bf16 v[40:43], v[120:123], v[88:91], v[40:43]
    s_waitcnt lgkmcnt(3)
    v_mfma_f32_16x16x32_bf16 v[44:47], v[152:155], v[88:91], v[44:47]
    s_waitcnt lgkmcnt(1)
    v_mfma_f32_16x16x32_bf16 v[40:43], v[124:127], v[92:95], v[40:43]
    s_waitcnt lgkmcnt(0)
    v_mfma_f32_16x16x32_bf16 v[44:47], v[156:159], v[92:95], v[44:47]
    s_nop 7
    v_cvt_pk_bf16_f32 v48, v43, v42
    v_cvt_pk_bf16_f32 v49, v41, v40
    v_cvt_pk_bf16_f32 v50, v42, v41
    v_cvt_pk_bf16_f32 v51, v44, v45
    v_cvt_pk_bf16_f32 v52, v46, v47
    ds_write_b64 v12, v[48:49] offset:2246
    ds_write_b32 v12, v50 offset:2
    v_readlane_b32 s44, v51, 0
    ds_write_b16 v12, v48
    ds_write_b16_d16_hi v12, v49 offset:6
    s_mov_b32 exec_lo, -2
    s_mov_b32 exec_hi, 1
    ds_write_b16 v13, v51 offset:96
    s_mov_b32 exec_lo, -1
    s_mov_b32 exec_hi, 0
    v_mov_b32 v53, s44
    ds_write_b16_d16_hi v13, v51 offset:64
    ds_write_b16 v13, v52 offset:32
    ds_write_b16_d16_hi v13, v52
    s_mov_b64 exec, 0x7f7f
    ds_write_b16 v14, v53
    s_mov_b64 exec, -1

    s_waitcnt lgkmcnt(0)
    s_barrier
    ds_read2_b32 v[128:129], v8 offset0:224 offset1:225
    ds_read2_b32 v[130:131], v8 offset0:226 offset1:227
    ds_read_b128 v[64:67], v7 offset:480
    ds_read_b128 v[68:71], v7 offset:992
    ds_read_b128 v[72:75], v7 offset:1504
    ds_read_b128 v[76:79], v7 offset:2016
    ds_read_b128 v[80:83], v7 offset:2528
    s_waitcnt lgkmcnt(4)
    v_mfma_f32_16x16x32_bf16 v[32:35], v[128:131], v[64:67], 0
    ds_read_b128 v[84:87], v7 offset:3040
    s_waitcnt lgkmcnt(4)
    v_mfma_f32_16x16x32_bf16 v[36:39], v[128:131], v[68:71], 0
    ds_read_b128 v[88:91], v7 offset:3552
    s_waitcnt lgkmcnt(4)
    v_mfma_f32_16x16x32_bf16 v[40:43], v[128:131], v[72:75], 0
    ds_read_b128 v[92:95], v7 offset:4064
    s_waitcnt lgkmcnt(4)
    v_mfma_f32_16x16x32_bf16 v[44:47], v[128:131], v[76:79], 0
    ds_read2_b32 v[132:133], v8 offset0:96 offset1:97
    s_waitcnt lgkmcnt(4)
    v_mfma_f32_16x16x32_bf16 v[48:51], v[128:131], v[80:83], 0
    ds_read2_b32 v[134:135], v8 offset0:98 offset1:99
    s_waitcnt lgkmcnt(4)
    v_mfma_f32_16x16x32_bf16 v[52:55], v[128:131], v[84:87], 0
    ds_read2_b32 v[136:137], v9 offset0:224 offset1:225
    s_waitcnt lgkmcnt(4)
    v_mfma_f32_16x16x32_bf16 v[56:59], v[128:131], v[88:91], 0
    ds_read2_b32 v[138:139], v9 offset0:226 offset1:227
    s_waitcnt lgkmcnt(4)
    v_mfma_f32_16x16x32_bf16 v[60:63], v[128:131], v[92:95], 0
    ds_read2_b32 v[140:141], v9 offset0:96 offset1:97
    s_waitcnt lgkmcnt(3)
    v_mfma_f32_16x16x32_bf16 v[36:39], v[132:135], v[64:67], v[36:39]
    ds_read2_b32 v[142:143], v9 offset0:98 offset1:99
    v_mfma_f32_16x16x32_bf16 v[40:43], v[132:135], v[68:71], v[40:43]
    ds_read2_b32 v[144:145], v10 offset0:0 offset1:1
    v_mfma_f32_16x16x32_bf16 v[44:47], v[132:135], v[72:75], v[44:47]
    ds_read2_b32 v[146:147], v10 offset0:2 offset1:3
    v_mfma_f32_16x16x32_bf16 v[48:51], v[132:135], v[76:79], v[48:51]
    ds_read2_b32 v[148:149], v8 offset0:192 offset1:193
    v_mfma_f32_16x16x32_bf16 v[52:55], v[132:135], v[80:83], v[52:55]
    ds_read2_b32 v[150:151], v8 offset0:194 offset1:195
    v_mfma_f32_16x16x32_bf16 v[56:59], v[132:135], v[84:87], v[56:59]
    ds_read_b128 v[96:99], v7 offset:352
    v_mfma_f32_16x16x32_bf16 v[60:63], v[132:135], v[88:91], v[60:63]
    ds_read_b128 v[100:103], v7 offset:864
    s_waitcnt lgkmcnt(6)
    v_mfma_f32_16x16x32_bf16 v[40:43], v[136:139], v[64:67], v[40:43]
    ds_read_b128 v[104:107], v7 offset:1376
    v_mfma_f32_16x16x32_bf16 v[44:47], v[136:139], v[68:71], v[44:47]
    ds_read_b128 v[108:111], v7 offset:1888
    v_mfma_f32_16x16x32_bf16 v[48:51], v[136:139], v[72:75], v[48:51]
    ds_read_b128 v[112:115], v7 offset:2400
    v_mfma_f32_16x16x32_bf16 v[52:55], v[136:139], v[76:79], v[52:55]
    ds_read_b128 v[116:119], v7 offset:2912
    v_mfma_f32_16x16x32_bf16 v[56:59], v[136:139], v[80:83], v[56:59]
    ds_read_b128 v[120:123], v7 offset:3424
    v_mfma_f32_16x16x32_bf16 v[60:63], v[136:139], v[84:87], v[60:63]
    ds_read_b128 v[124:127], v7 offset:3936
    v_mfma_f32_16x16x32_bf16 v[44:47], v[140:143], v[64:67], v[44:47]
    ds_read2_b32 v[152:153], v8 offset0:64 offset1:65
    v_mfma_f32_16x16x32_bf16 v[48:51], v[140:143], v[68:71], v[48:51]
    ds_read2_b32 v[154:155], v8 offset0:66 offset1:67
    v_mfma_f32_16x16x32_bf16 v[52:55], v[140:143], v[72:75], v[52:55]
    ds_read2_b32 v[156:157], v9 offset0:192 offset1:193
    v_mfma_f32_16x16x32_bf16 v[56:59], v[140:143], v[76:79], v[56:59]
    ds_read2_b32 v[158:159], v9 offset0:194 offset1:195
    v_mfma_f32_16x16x32_bf16 v[60:63], v[140:143], v[80:83], v[60:63]
    ds_read2_b32 v[160:161], v9 offset0:64 offset1:65
    s_waitcnt lgkmcnt(6)
    v_mfma_f32_16x16x32_bf16 v[48:51], v[144:147], v[64:67], v[48:51]
    ds_read2_b32 v[162:163], v9 offset0:66 offset1:67
    v_mfma_f32_16x16x32_bf16 v[52:55], v[144:147], v[68:71], v[52:55]
    v_mfma_f32_16x16x32_bf16 v[56:59], v[144:147], v[72:75], v[56:59]
    v_mfma_f32_16x16x32_bf16 v[60:63], v[144:147], v[76:79], v[60:63]
    v_mfma_f32_16x16x32_bf16 v[32:35], v[148:151], v[96:99], v[32:35]
    ds_read2_b32 v[128:129], v8 offset0:160 offset1:161
    v_mfma_f32_16x16x32_bf16 v[36:39], v[148:151], v[100:103], v[36:39]
    ds_read2_b32 v[130:131], v8 offset0:162 offset1:163
    v_mfma_f32_16x16x32_bf16 v[40:43], v[148:151], v[104:107], v[40:43]
    ds_read_b128 v[80:83], v7 offset:2272
    v_mfma_f32_16x16x32_bf16 v[44:47], v[148:151], v[108:111], v[44:47]
    ds_read_b128 v[84:87], v7 offset:2784
    v_mfma_f32_16x16x32_bf16 v[48:51], v[148:151], v[112:115], v[48:51]
    ds_read_b128 v[88:91], v7 offset:3296
    v_mfma_f32_16x16x32_bf16 v[52:55], v[148:151], v[116:119], v[52:55]
    ds_read_b128 v[92:95], v7 offset:3808
    v_mfma_f32_16x16x32_bf16 v[56:59], v[148:151], v[120:123], v[56:59]
    ds_read2_b32 v[132:133], v8 offset0:32 offset1:33
    s_waitcnt lgkmcnt(6)
    v_mfma_f32_16x16x32_bf16 v[60:63], v[148:151], v[124:127], v[60:63]
    ds_read2_b32 v[134:135], v8 offset0:34 offset1:35
    v_mfma_f32_16x16x32_bf16 v[36:39], v[152:155], v[96:99], v[36:39]
    ds_read_b128 v[76:79], v7 offset:1760
    v_mfma_f32_16x16x32_bf16 v[40:43], v[152:155], v[100:103], v[40:43]
    ds_read2_b32 v[136:137], v9 offset0:160 offset1:161
    v_mfma_f32_16x16x32_bf16 v[44:47], v[152:155], v[104:107], v[44:47]
    ds_read2_b32 v[138:139], v9 offset0:162 offset1:163
    v_mfma_f32_16x16x32_bf16 v[48:51], v[152:155], v[108:111], v[48:51]
    ds_read_b128 v[72:75], v7 offset:1248
    v_mfma_f32_16x16x32_bf16 v[52:55], v[152:155], v[112:115], v[52:55]
    ds_read2_b32 v[140:141], v9 offset0:32 offset1:33
    v_mfma_f32_16x16x32_bf16 v[56:59], v[152:155], v[116:119], v[56:59]
    ds_read2_b32 v[142:143], v9 offset0:34 offset1:35
    v_mfma_f32_16x16x32_bf16 v[60:63], v[152:155], v[120:123], v[60:63]
    ds_read_b128 v[68:71], v7 offset:736
    v_mfma_f32_16x16x32_bf16 v[40:43], v[156:159], v[96:99], v[40:43]
    ds_read_b128 v[64:67], v7 offset:224
    v_mfma_f32_16x16x32_bf16 v[44:47], v[156:159], v[100:103], v[44:47]
    ds_read_b128 v[168:171], v7 offset:1488
    v_mfma_f32_16x16x32_bf16 v[48:51], v[156:159], v[104:107], v[48:51]
    ds_read_b128 v[172:175], v7 offset:1504
    v_mfma_f32_16x16x32_bf16 v[52:55], v[156:159], v[108:111], v[52:55]
    ds_read_b128 v[176:179], v7 offset:2000
    v_mfma_f32_16x16x32_bf16 v[56:59], v[156:159], v[112:115], v[56:59]
    ds_read_b128 v[180:183], v7 offset:2016
    v_mfma_f32_16x16x32_bf16 v[60:63], v[156:159], v[116:119], v[60:63]
    ds_read2_b32 v[208:209], v11 offset0:48 offset1:49
    v_mfma_f32_16x16x32_bf16 v[44:47], v[160:163], v[96:99], v[44:47]
    ds_read2_b32 v[210:211], v11 offset0:50 offset1:51
    v_mfma_f32_16x16x32_bf16 v[48:51], v[160:163], v[100:103], v[48:51]
    ds_read2_b32 v[212:213], v11 offset0:32 offset1:33
    v_mfma_f32_16x16x32_bf16 v[52:55], v[160:163], v[104:107], v[52:55]
    ds_read2_b32 v[214:215], v11 offset0:34 offset1:35
    v_mfma_f32_16x16x32_bf16 v[56:59], v[160:163], v[108:111], v[56:59]
    v_mfma_f32_16x16x32_bf16 v[60:63], v[160:163], v[112:115], v[60:63]
    s_waitcnt lgkmcnt(4)
    v_mfma_f32_16x16x32_bf16 v[48:51], v[128:131], v[80:83], v[48:51]
    ds_read2_b32 v[148:149], v8 offset0:128 offset1:129
    v_mfma_f32_16x16x32_bf16 v[52:55], v[128:131], v[84:87], v[52:55]
    ds_read2_b32 v[150:151], v8 offset0:130 offset1:131
    v_mfma_f32_16x16x32_bf16 v[184:187], v[168:171], v[224:227], 0
    v_mfma_f32_16x16x32_bf16 v[188:191], v[172:175], v[228:231], 0
    ds_read_b128 v[112:115], v7 offset:2144
    ds_read_b128 v[116:119], v7 offset:2656
    v_mfma_f32_16x16x32_bf16 v[192:195], v[176:179], v[224:227], 0
    v_mfma_f32_16x16x32_bf16 v[196:199], v[180:183], v[228:231], 0
    ds_read_b128 v[120:123], v7 offset:3168
    ds_read_b128 v[124:127], v7 offset:3680
    v_mfma_f32_16x16x32_bf16 v[56:59], v[128:131], v[88:91], v[56:59]
    ds_read2_b32 v[152:153], v8 offset0:0 offset1:1
    v_mfma_f32_16x16x32_bf16 v[60:63], v[128:131], v[92:95], v[60:63]
    ds_read2_b32 v[154:155], v8 offset0:2 offset1:3
    v_mfma_f32_16x16x32_bf16 v[48:51], v[132:135], v[76:79], v[48:51]
    ds_read_b128 v[108:111], v7 offset:1632
    v_mfma_f32_16x16x32_bf16 v[52:55], v[132:135], v[80:83], v[52:55]
    ds_read2_b32 v[156:157], v9 offset0:128 offset1:129
    v_mfma_f32_16x16x32_bf16 v[56:59], v[132:135], v[84:87], v[56:59]
    ds_read2_b32 v[158:159], v9 offset0:130 offset1:131
    v_mfma_f32_16x16x32_bf16 v[60:63], v[132:135], v[88:91], v[60:63]
    ds_read_b128 v[104:107], v7 offset:1120
    v_cvt_pk_bf16_f32 v200, v184, v188
    v_cvt_pk_bf16_f32 v204, v192, v196
    v_mfma_f32_16x16x32_bf16 v[48:51], v[136:139], v[72:75], v[48:51]
    ds_read2_b32 v[160:161], v9 offset0:0 offset1:1
    v_cvt_pk_bf16_f32 v201, v185, v189
    v_cvt_pk_bf16_f32 v205, v193, v197
    v_mfma_f32_16x16x32_bf16 v[52:55], v[136:139], v[76:79], v[52:55]
    ds_read2_b32 v[162:163], v9 offset0:2 offset1:3
    v_cvt_pk_bf16_f32 v202, v186, v190
    v_cvt_pk_bf16_f32 v206, v194, v198
    v_mfma_f32_16x16x32_bf16 v[56:59], v[136:139], v[80:83], v[56:59]
    ds_read_b128 v[100:103], v7 offset:608
    v_cvt_pk_bf16_f32 v203, v187, v191
    v_cvt_pk_bf16_f32 v207, v195, v199
    v_mfma_f32_16x16x32_bf16 v[60:63], v[136:139], v[84:87], v[60:63]
    ds_read_b128 v[96:99], v7 offset:96
    v_mfma_f32_16x16x32_bf16 v[48:51], v[140:143], v[68:71], v[48:51]
    v_mfma_f32_16x16x32_bf16 v[52:55], v[140:143], v[72:75], v[52:55]
    v_mfma_f32_16x16x32_bf16 v[56:59], v[140:143], v[76:79], v[56:59]
    v_mfma_f32_16x16x32_bf16 v[60:63], v[140:143], v[80:83], v[60:63]
    s_waitcnt lgkmcnt(2)
    v_mfma_f32_16x16x32_bf16 v[56:59], v[200:203], v[208:211], v[56:59]
    v_mfma_f32_16x16x32_bf16 v[60:63], v[200:203], v[212:215], v[60:63]
    v_mfma_f32_16x16x32_bf16 v[60:63], v[204:207], v[208:211], v[60:63]
    v_mfma_f32_16x16x32_bf16 v[48:51], v[148:151], v[112:115], v[48:51]
    v_mfma_f32_16x16x32_bf16 v[52:55], v[148:151], v[116:119], v[52:55]
    v_mfma_f32_16x16x32_bf16 v[56:59], v[148:151], v[120:123], v[56:59]
    v_mfma_f32_16x16x32_bf16 v[60:63], v[148:151], v[124:127], v[60:63]
    v_mfma_f32_16x16x32_bf16 v[48:51], v[152:155], v[108:111], v[48:51]
    v_mfma_f32_16x16x32_bf16 v[52:55], v[152:155], v[112:115], v[52:55]
    v_mfma_f32_16x16x32_bf16 v[56:59], v[152:155], v[116:119], v[56:59]
    v_mfma_f32_16x16x32_bf16 v[60:63], v[152:155], v[120:123], v[60:63]
    v_mfma_f32_16x16x32_bf16 v[48:51], v[156:159], v[104:107], v[48:51]
    v_mfma_f32_16x16x32_bf16 v[52:55], v[156:159], v[108:111], v[52:55]
    v_mfma_f32_16x16x32_bf16 v[56:59], v[156:159], v[112:115], v[56:59]
    v_mfma_f32_16x16x32_bf16 v[60:63], v[156:159], v[116:119], v[60:63]
    s_waitcnt lgkmcnt(0)
    v_mfma_f32_16x16x32_bf16 v[48:51], v[160:163], v[100:103], v[48:51]
    v_mfma_f32_16x16x32_bf16 v[52:55], v[160:163], v[104:107], v[52:55]
    v_mfma_f32_16x16x32_bf16 v[56:59], v[160:163], v[108:111], v[56:59]
    v_mfma_f32_16x16x32_bf16 v[60:63], v[160:163], v[112:115], v[60:63]
    ds_write_b128 v232, v[48:51] offset:0
    v_mfma_f32_16x16x32_bf16 v[32:35], v[128:131], v[64:67], v[32:35]
    ds_write_b128 v232, v[52:55] offset:1024
    v_mfma_f32_16x16x32_bf16 v[36:39], v[128:131], v[68:71], v[36:39]
    ds_write_b128 v232, v[56:59] offset:2048
    v_mfma_f32_16x16x32_bf16 v[40:43], v[128:131], v[72:75], v[40:43]
    ds_write_b128 v232, v[60:63] offset:3072
    ds_write_b32 v239, v238 offset:62048
    v_mfma_f32_16x16x32_bf16 v[44:47], v[128:131], v[76:79], v[44:47]
    v_mfma_f32_16x16x32_bf16 v[36:39], v[132:135], v[64:67], v[36:39]
    v_mfma_f32_16x16x32_bf16 v[40:43], v[132:135], v[68:71], v[40:43]
    v_mfma_f32_16x16x32_bf16 v[44:47], v[132:135], v[72:75], v[44:47]
    ds_read_b32 v234, v235 offset:62016
    ds_read_b128 v[168:171], v233 offset:0
    ds_read_b128 v[172:175], v233 offset:1024
    ds_read_b128 v[176:179], v233 offset:2048
    ds_read_b128 v[180:183], v233 offset:3072
    ds_read_b128 v[208:211], v238
    ds_read_b128 v[212:215], v238 offset:2048
    v_mfma_f32_16x16x32_bf16 v[40:43], v[136:139], v[64:67], v[40:43]
    v_mfma_f32_16x16x32_bf16 v[44:47], v[136:139], v[68:71], v[44:47]
    v_mfma_f32_16x16x32_bf16 v[44:47], v[140:143], v[64:67], v[44:47]
    v_mfma_f32_16x16x32_bf16 v[32:35], v[148:151], v[96:99], v[32:35]
    v_mfma_f32_16x16x32_bf16 v[36:39], v[148:151], v[100:103], v[36:39]
    v_mfma_f32_16x16x32_bf16 v[36:39], v[152:155], v[96:99], v[36:39]
    v_mfma_f32_16x16x32_bf16 v[40:43], v[148:151], v[104:107], v[40:43]
    s_waitcnt lgkmcnt(0)
    v_cmp_eq_u32 vcc, 0, v234
    s_and_b32 s44, vcc_lo, s55
    s_cbranch_scc1 L_retry0
L_back0:
    v_readfirstlane_b32 s49, v234

    v_pk_add_f32 v[32:33], v[32:33], v[168:169]
    v_pk_add_f32 v[34:35], v[34:35], v[170:171]
    v_cvt_pk_bf16_f32 v200, v32, v33
    v_cvt_pk_bf16_f32 v201, v34, v35

    v_mfma_f32_16x16x32_bf16 v[40:43], v[152:155], v[100:103], v[40:43]
    v_mfma_f32_16x16x32_bf16 v[40:43], v[156:159], v[96:99], v[40:43]
    v_pk_add_f32 v[36:37], v[36:37], v[172:173]
    v_pk_add_f32 v[38:39], v[38:39], v[174:175]
    v_cvt_pk_bf16_f32 v202, v36, v37
    v_cvt_pk_bf16_f32 v203, v38, v39

    s_nop 0
    s_cmp_lg_u32 s49, 0
    v_permlane16_swap_b32 v200, v202
    v_permlane16_swap_b32 v201, v203

    v_xnor_b32 v200, v200, v208
    v_xnor_b32 v202, v202, v210
    v_xnor_b32 v201, v201, v209
    v_xnor_b32 v203, v203, v211
    s_cbranch_scc1 L_sl0_0
    buffer_store_dwordx4 v[200:203], v15, s[12:15], s47 offen
L_bk0_0:

    v_mfma_f32_16x16x32_bf16 v[44:47], v[148:151], v[108:111], v[44:47]
    v_mfma_f32_16x16x32_bf16 v[44:47], v[152:155], v[104:107], v[44:47]
    v_mfma_f32_16x16x32_bf16 v[44:47], v[156:159], v[100:103], v[44:47]
    v_pk_add_f32 v[40:41], v[40:41], v[176:177]
    v_pk_add_f32 v[42:43], v[42:43], v[178:179]
    v_cvt_pk_bf16_f32 v204, v40, v41
    v_cvt_pk_bf16_f32 v205, v42, v43

    v_mfma_f32_16x16x32_bf16 v[44:47], v[160:163], v[96:99], v[44:47]
    s_nop 7
    v_pk_add_f32 v[44:45], v[44:45], v[180:181]
    v_pk_add_f32 v[46:47], v[46:47], v[182:183]
    v_cvt_pk_bf16_f32 v206, v44, v45
    v_cvt_pk_bf16_f32 v207, v46, v47

    s_nop 0
    s_cmp_lg_u32 s49, 0
    v_permlane16_swap_b32 v204, v206
    v_permlane16_swap_b32 v205, v207

    v_xnor_b32 v204, v204, v212
    v_xnor_b32 v206, v206, v214
    v_xnor_b32 v205, v205, v213
    v_xnor_b32 v207, v207, v215
    s_cbranch_scc1 L_sl0_1
    buffer_store_dwordx4 v[204:207], v15, s[12:15], s48 offen
L_bk0_1:

    s_barrier
    s_endpgm
L_retry0:

    ds_read_b32 v234, v235 offset:62016
    ds_read_b128 v[168:171], v233 offset:0
    ds_read_b128 v[172:175], v233 offset:1024
    ds_read_b128 v[176:179], v233 offset:2048
    ds_read_b128 v[180:183], v233 offset:3072
    ds_read_b128 v[208:211], v238
    ds_read_b128 v[212:215], v238 offset:2048
    s_waitcnt lgkmcnt(0)
    v_cmp_eq_u32 vcc, 0, v234
    s_and_b32 s44, vcc_lo, s55
    s_cbranch_scc1 L_retry0
    s_branch L_back0
L_sl0_0:
    s_add_u32 s12, s20, 4194304
    s_addc_u32 s13, s21, 0
    buffer_store_dwordx4 v[200:203], v15, s[12:15], s47 offen sc0 sc1
    s_branch L_bk0_0
L_sl0_1:

    s_branch L_sl1_1
L_kO:
    ds_read_b128 v[64:67], v6 offset:22304
    ds_read_b128 v[96:99], v6 offset:8704
    ds_read_b128 v[68:71], v6 offset:22368
    ds_read_b128 v[100:103], v6 offset:8768
    ds_read_b128 v[72:75], v6 offset:22432
    ds_read_b128 v[104:107], v6 offset:8832
    ds_read_b128 v[76:79], v6 offset:22496
    ds_read_b128 v[108:111], v6 offset:8896
    ds_read_b128 v[80:83], v6 offset:22560
    ds_read_b128 v[112:115], v6 offset:8960
    ds_read_b128 v[84:87], v6 offset:22624
    ds_read_b128 v[116:119], v6 offset:9024
    s_waitcnt lgkmcnt(10)
    v_mfma_f32_16x16x32_bf16 v[40:43], v[96:99], v[64:67], 0
    ds_read_b128 v[88:91], v6 offset:22688
    ds_read_b128 v[120:123], v6 offset:9088
    s_waitcnt lgkmcnt(10)
    v_mfma_f32_16x16x32_bf16 v[40:43], v[100:103], v[68:71], v[40:43]
    ds_read_b128 v[92:95], v6 offset:22752
    ds_read_b128 v[124:127], v6 offset:9152
    s_waitcnt lgkmcnt(10)
    v_mfma_f32_16x16x32_bf16 v[40:43], v[104:107], v[72:75], v[40:43]
    s_waitcnt lgkmcnt(8)
    v_mfma_f32_16x16x32_bf16 v[40:43], v[108:111], v[76:79], v[40:43]
    s_waitcnt lgkmcnt(6)
    v_mfma_f32_16x16x32_bf16 v[40:43], v[112:115], v[80:83], v[40:43]
    s_waitcnt lgkmcnt(4)
    v_mfma_f32_16x16x32_bf16 v[40:43], v[116:119], v[84:87], v[40:43]
    s_waitcnt lgkmcnt(2)
    v_mfma_f32_16x16x32_bf16 v[40:43], v[120:123], v[88:91], v[40:43]
    s_waitcnt lgkmcnt(0)
    v_mfma_f32_16x16x32_bf16 v[40:43], v[124:127], v[92:95], v[40:43]
    s_nop 7
    v_cvt_pk_bf16_f32 v48, v40, v40
    v_cvt_pk_bf16_f32 v49, v41, v41
    v_cvt_pk_bf16_f32 v50, v41, v40
    v_cvt_pk_bf16_f32 v51, v42, v42
    v_cvt_pk_bf16_f32 v52, v43, v43
    v_cvt_pk_bf16_f32 v53, v43, v42
    v_cvt_pk_bf16_f32 v54, v42, v41
    s_mov_b32 exec_lo, 0

    ds_write_b16 v12, v49 offset:258
    ds_write2_b32 v12, v49, v48 offset0:65 offset1:66
    ds_write_b32 v12, v48 offset:268
    ds_write_b16 v12, v48 offset:272
    ds_write2_b32 v13, v49, v50 offset0:65 offset1:66
    ds_write2_b32 v13, v48, v48 offset0:67 offset1:68

    ds_write_b16 v12, v52 offset:2
    ds_write2_b32 v12, v52, v51 offset0:1 offset1:2
    ds_write_b32 v12, v51 offset:12
    ds_write_b16 v12, v51 offset:16
    ds_write2_b32 v13, v52, v53 offset0:1 offset1:2
    ds_write2_b32 v13, v51, v51 offset0:3 offset1:4

    s_mov_b32 exec_lo, -1
    s_mov_b32 exec_hi, 0
    ds_write2_b32 v12, v53, v51 offset0:0 offset1:1
    ds_write_b32 v12, v50 offset:8
    ds_write_b16 v12, v48 offset:12
    ds_write_b16 v13, v53 offset:2
    ds_write2_b32 v13, v51, v54 offset0:1 offset1:2
    ds_write_b32 v13, v48 offset:12
    s_mov_b32 exec_lo, -2
    ds_write_b16 v12, v48 offset:14
    ds_write_b16 v13, v48 offset:16
    s_mov_b64 exec, -1

    s_waitcnt lgkmcnt(0)
    s_barrier
    ds_read2_b32 v[128:129], v8 offset0:224 offset1:225
    ds_read2_b32 v[130:131], v8 offset0:226 offset1:227
    ds_read_b128 v[64:67], v7 offset:416
    ds_read_b128 v[68:71], v7 offset:928
    ds_read_b128 v[72:75], v7 offset:1440
    ds_read_b128 v[76:79], v7 offset:1952
    ds_read_b128 v[80:83], v7 offset:2464
    s_waitcnt lgkmcnt(4)
    v_mfma_f32_16x16x32_bf16 v[32:35], v[128:131], v[64:67], 0
    ds_read_b128 v[84:87], v7 offset:2976
    s_waitcnt lgkmcnt(4)
    v_mfma_f32_16x16x32_bf16 v[36:39], v[128:131], v[68:71], 0
    ds_read_b128 v[88:91], v7 offset:3488
    s_waitcnt lgkmcnt(4)
    v_mfma_f32_16x16x32_bf16 v[40:43], v[128:131], v[72:75], 0
    ds_read_b128 v[92:95], v7 offset:4000
    s_waitcnt lgkmcnt(4)
    v_mfma_f32_16x16x32_bf16 v[44:47], v[128:131], v[76:79], 0
    ds_read2_b32 v[132:133], v8 offset0:96 offset1:97
    s_waitcnt lgkmcnt(4)
    v_mfma_f32_16x16x32_bf16 v[48:51], v[128:131], v[80:83], 0
    ds_read2_b32 v[134:135], v8 offset0:98 offset1:99
    s_waitcnt lgkmcnt(4)
    v_mfma_f32_16x16x32_bf16 v[52:55], v[128:131], v[84:87], 0
    ds_read2_b32 v[136:137], v9 offset0:224 offset1:225
    s_waitcnt lgkmcnt(4)
    v_mfma_f32_16x16x32_bf16 v[56:59], v[128:131], v[88:91], 0
    ds_read2_b32 v[138:139], v9 offset0:226 offset1:227
    s_waitcnt lgkmcnt(4)
    v_mfma_f32_16x16x32_bf16 v[60:63], v[128:131], v[92:95], 0
    ds_read2_b32 v[140:141], v9 offset0:96 offset1:97
    s_waitcnt lgkmcnt(3)
    v_mfma_f32_16x16x32_bf16 v[36:39], v[132:135], v[64:67], v[36:39]
    ds_read2_b32 v[142:143], v9 offset0:98 offset1:99
    v_mfma_f32_16x16x32_bf16 v[40:43], v[132:135], v[68:71], v[40:43]
    ds_read2_b32 v[148:149], v8 offset0:192 offset1:193
    v_mfma_f32_16x16x32_bf16 v[44:47], v[132:135], v[72:75], v[44:47]
    ds_read2_b32 v[150:151], v8 offset0:194 offset1:195
    v_mfma_f32_16x16x32_bf16 v[48:51], v[132:135], v[76:79], v[48:51]
    ds_read_b128 v[96:99], v7 offset:288
    v_mfma_f32_16x16x32_bf16 v[52:55], v[132:135], v[80:83], v[52:55]
    ds_read_b128 v[100:103], v7 offset:800
    v_mfma_f32_16x16x32_bf16 v[56:59], v[132:135], v[84:87], v[56:59]
    ds_read_b128 v[104:107], v7 offset:1312
    v_mfma_f32_16x16x32_bf16 v[60:63], v[132:135], v[88:91], v[60:63]
    ds_read_b128 v[108:111], v7 offset:1824
    s_waitcnt lgkmcnt(6)
    v_mfma_f32_16x16x32_bf16 v[40:43], v[136:139], v[64:67], v[40:43]
    ds_read_b128 v[112:115], v7 offset:2336
    v_mfma_f32_16x16x32_bf16 v[44:47], v[136:139], v[68:71], v[44:47]
    ds_read_b128 v[116:119], v7 offset:2848
    v_mfma_f32_16x16x32_bf16 v[48:51], v[136:139], v[72:75], v[48:51]
    ds_read_b128 v[120:123], v7 offset:3360
    v_mfma_f32_16x16x32_bf16 v[52:55], v[136:139], v[76:79], v[52:55]
    ds_read_b128 v[124:127], v7 offset:3872
    v_mfma_f32_16x16x32_bf16 v[56:59], v[136:139], v[80:83], v[56:59]
    ds_read2_b32 v[152:153], v8 offset0:64 offset1:65
    v_mfma_f32_16x16x32_bf16 v[60:63], v[136:139], v[84:87], v[60:63]
    ds_read2_b32 v[154:155], v8 offset0:66 offset1:67
    v_mfma_f32_16x16x32_bf16 v[44:47], v[140:143], v[64:67], v[44:47]
    ds_read2_b32 v[156:157], v9 offset0:192 offset1:193
    v_mfma_f32_16x16x32_bf16 v[48:51], v[140:143], v[68:71], v[48:51]
    ds_read2_b32 v[158:159], v9 offset0:194 offset1:195
    v_mfma_f32_16x16x32_bf16 v[52:55], v[140:143], v[72:75], v[52:55]
    ds_read2_b32 v[160:161], v9 offset0:64 offset1:65
    v_mfma_f32_16x16x32_bf16 v[56:59], v[140:143], v[76:79], v[56:59]
    ds_read2_b32 v[162:163], v9 offset0:66 offset1:67
    v_mfma_f32_16x16x32_bf16 v[60:63], v[140:143], v[80:83], v[60:63]
    s_waitcnt lgkmcnt(5)
    v_mfma_f32_16x16x32_bf16 v[32:35], v[148:151], v[96:99], v[32:35]
    ds_read2_b32 v[128:129], v8 offset0:160 offset1:161
    v_mfma_f32_16x16x32_bf16 v[36:39], v[148:151], v[100:103], v[36:39]
    ds_read2_b32 v[130:131], v8 offset0:162 offset1:163
    v_mfma_f32_16x16x32_bf16 v[40:43], v[148:151], v[104:107], v[40:43]
    ds_read_b128 v[64:67], v7 offset:160
    v_mfma_f32_16x16x32_bf16 v[44:47], v[148:151], v[108:111], v[44:47]
    ds_read_b128 v[68:71], v7 offset:672
    v_mfma_f32_16x16x32_bf16 v[48:51], v[148:151], v[112:115], v[48:51]
    ds_read_b128 v[72:75], v7 offset:1184
    v_mfma_f32_16x16x32_bf16 v[52:55], v[148:151], v[116:119], v[52:55]
    ds_read_b128 v[76:79], v7 offset:1696
    v_mfma_f32_16x16x32_bf16 v[56:59], v[148:151], v[120:123], v[56:59]
    ds_read2_b32 v[132:133], v8 offset0:32 offset1:33
    v_mfma_f32_16x16x32_bf16 v[60:63], v[148:151], v[124:127], v[60:63]
    ds_read2_b32 v[134:135], v8 offset0:34 offset1:35
    s_waitcnt lgkmcnt(6)
    v_mfma_f32_16x16x32_bf16 v[36:39], v[152:155], v[96:99], v[36:39]
    ds_read_b128 v[80:83], v7 offset:2208
    v_mfma_f32_16x16x32_bf16 v[40:43], v[152:155], v[100:103], v[40:43]
    ds_read2_b32 v[136:137], v9 offset0:160 offset1:161
    v_mfma_f32_16x16x32_bf16 v[44:47], v[152:155], v[104:107], v[44:47]
    ds_read2_b32 v[138:139], v9 offset0:162 offset1:163
    v_mfma_f32_16x16x32_bf16 v[48:51], v[152:155], v[108:111], v[48:51]
    ds_read_b128 v[84:87], v7 offset:2720
    v_mfma_f32_16x16x32_bf16 v[52:55], v[152:155], v[112:115], v[52:55]
    ds_read2_b32 v[140:141], v9 offset0:32 offset1:33
    v_mfma_f32_16x16x32_bf16 v[56:59], v[152:155], v[116:119], v[56:59]
    ds_read2_b32 v[142:143], v9 offset0:34 offset1:35
    v_mfma_f32_16x16x32_bf16 v[60:63], v[152:155], v[120:123], v[60:63]
    ds_read_b128 v[88:91], v7 offset:3232
    v_mfma_f32_16x16x32_bf16 v[40:43], v[156:159], v[96:99], v[40:43]
    ds_read_b128 v[92:95], v7 offset:3744
    v_mfma_f32_16x16x32_bf16 v[44:47], v[156:159], v[100:103], v[44:47]
    ds_read_b128 v[168:171], v7 offset:464
    v_mfma_f32_16x16x32_bf16 v[48:51], v[156:159], v[104:107], v[48:51]
    ds_read_b128 v[172:175], v7 offset:480
    v_mfma_f32_16x16x32_bf16 v[52:55], v[156:159], v[108:111], v[52:55]
    ds_read_b128 v[176:179], v7 offset:976
    v_mfma_f32_16x16x32_bf16 v[56:59], v[156:159], v[112:115], v[56:59]
    ds_read_b128 v[180:183], v7 offset:992
    v_mfma_f32_16x16x32_bf16 v[60:63], v[156:159], v[116:119], v[60:63]
    ds_read2_b32 v[208:209], v11 offset0:48 offset1:49
    v_mfma_f32_16x16x32_bf16 v[44:47], v[160:163], v[96:99], v[44:47]
    ds_read2_b32 v[210:211], v11 offset0:50 offset1:51
    v_mfma_f32_16x16x32_bf16 v[48:51], v[160:163], v[100:103], v[48:51]
    ds_read2_b32 v[212:213], v11 offset0:32 offset1:33
    v_mfma_f32_16x16x32_bf16 v[52:55], v[160:163], v[104:107], v[52:55]
    ds_read2_b32 v[214:215], v11 offset0:34 offset1:35
    v_mfma_f32_16x16x32_bf16 v[56:59], v[160:163], v[108:111], v[56:59]
    v_mfma_f32_16x16x32_bf16 v[60:63], v[160:163], v[112:115], v[60:63]
    s_waitcnt lgkmcnt(4)
    v_mfma_f32_16x16x32_bf16 v[32:35], v[128:131], v[64:67], v[32:35]
    ds_read2_b32 v[216:217], v11 offset0:16 offset1:17
    v_mfma_f32_16x16x32_bf16 v[36:39], v[128:131], v[68:71], v[36:39]
    ds_read2_b32 v[218:219], v11 offset0:18 offset1:19
    v_mfma_f32_16x16x32_bf16 v[184:187], v[168:171], v[224:227], 0
    v_mfma_f32_16x16x32_bf16 v[188:191], v[172:175], v[228:231], 0
    ds_read2_b32 v[220:221], v11 offset0:0 offset1:1
    ds_read2_b32 v[222:223], v11 offset0:2 offset1:3
    v_mfma_f32_16x16x32_bf16 v[192:195], v[176:179], v[224:227], 0
    v_mfma_f32_16x16x32_bf16 v[196:199], v[180:183], v[228:231], 0
    ds_read2_b32 v[148:149], v8 offset0:128 offset1:129
    ds_read2_b32 v[150:151], v8 offset0:130 offset1:131
    v_mfma_f32_16x16x32_bf16 v[40:43], v[128:131], v[72:75], v[40:43]
    ds_read_b128 v[96:99], v7 offset:32
    v_mfma_f32_16x16x32_bf16 v[44:47], v[128:131], v[76:79], v[44:47]
    ds_read_b128 v[100:103], v7 offset:544
    v_mfma_f32_16x16x32_bf16 v[36:39], v[132:135], v[64:67], v[36:39]
    ds_read_b128 v[104:107], v7 offset:1056
    v_mfma_f32_16x16x32_bf16 v[40:43], v[132:135], v[68:71], v[40:43]
    ds_read_b128 v[108:111], v7 offset:1568
    v_cvt_pk_bf16_f32 v200, v184, v188
    v_cvt_pk_bf16_f32 v204, v192, v196
    v_mfma_f32_16x16x32_bf16 v[44:47], v[132:135], v[72:75], v[44:47]
    ds_read2_b32 v[152:153], v8 offset0:0 offset1:1
    v_cvt_pk_bf16_f32 v201, v185, v189
    v_cvt_pk_bf16_f32 v205, v193, v197
    v_mfma_f32_16x16x32_bf16 v[40:43], v[136:139], v[64:67], v[40:43]
    ds_read2_b32 v[154:155], v8 offset0:2 offset1:3
    v_cvt_pk_bf16_f32 v202, v186, v190
    v_cvt_pk_bf16_f32 v206, v194, v198
    v_mfma_f32_16x16x32_bf16 v[44:47], v[136:139], v[68:71], v[44:47]
    ds_read_b128 v[112:115], v7 offset:2080
    v_cvt_pk_bf16_f32 v203, v187, v191
    v_cvt_pk_bf16_f32 v207, v195, v199
    v_mfma_f32_16x16x32_bf16 v[44:47], v[140:143], v[64:67], v[44:47]
    ds_read2_b32 v[156:157], v9 offset0:128 offset1:129
    s_waitcnt lgkmcnt(6)
    v_mfma_f32_16x16x32_bf16 v[48:51], v[200:203], v[208:211], v[48:51]
    ds_read2_b32 v[158:159], v9 offset0:130 offset1:131
    v_mfma_f32_16x16x32_bf16 v[52:55], v[200:203], v[212:215], v[52:55]
    ds_read_b128 v[116:119], v7 offset:2592
    v_mfma_f32_16x16x32_bf16 v[56:59], v[200:203], v[216:219], v[56:59]
    ds_read2_b32 v[160:161], v9 offset0:0 offset1:1
    v_mfma_f32_16x16x32_bf16 v[60:63], v[200:203], v[220:223], v[60:63]
    ds_read2_b32 v[162:163], v9 offset0:2 offset1:3
    v_mfma_f32_16x16x32_bf16 v[52:55], v[204:207], v[208:211], v[52:55]
    ds_read_b128 v[120:123], v7 offset:3104
    v_mfma_f32_16x16x32_bf16 v[56:59], v[204:207], v[212:215], v[56:59]
    ds_read_b128 v[124:127], v7 offset:3616
    v_mfma_f32_16x16x32_bf16 v[60:63], v[204:207], v[216:219], v[60:63]
    v_mfma_f32_16x16x32_bf16 v[32:35], v[148:151], v[96:99], v[32:35]
    v_mfma_f32_16x16x32_bf16 v[36:39], v[148:151], v[100:103], v[36:39]
    s_waitcnt lgkmcnt(3)
    v_mfma_f32_16x16x32_bf16 v[40:43], v[148:151], v[104:107], v[40:43]
    v_mfma_f32_16x16x32_bf16 v[44:47], v[148:151], v[108:111], v[44:47]
    v_mfma_f32_16x16x32_bf16 v[36:39], v[152:155], v[96:99], v[36:39]
    v_mfma_f32_16x16x32_bf16 v[40:43], v[152:155], v[100:103], v[40:43]
    v_mfma_f32_16x16x32_bf16 v[44:47], v[152:155], v[104:107], v[44:47]
    v_mfma_f32_16x16x32_bf16 v[40:43], v[156:159], v[96:99], v[40:43]
    v_mfma_f32_16x16x32_bf16 v[44:47], v[156:159], v[100:103], v[44:47]
    s_waitcnt lgkmcnt(0)
    v_mfma_f32_16x16x32_bf16 v[44:47], v[160:163], v[96:99], v[44:47]
    v_mfma_f32_16x16x32_bf16 v[48:51], v[128:131], v[80:83], v[48:51]
    v_mfma_f32_16x16x32_bf16 v[52:55], v[128:131], v[84:87], v[52:55]
    v_mfma_f32_16x16x32_bf16 v[56:59], v[128:131], v[88:91], v[56:59]
    v_mfma_f32_16x16x32_bf16 v[60:63], v[128:131], v[92:95], v[60:63]
    ds_write_b128 v232, v[32:35] offset:0
    v_mfma_f32_16x16x32_bf16 v[48:51], v[132:135], v[76:79], v[48:51]
    ds_write_b128 v232, v[36:39] offset:1024
    v_mfma_f32_16x16x32_bf16 v[52:55], v[132:135], v[80:83], v[52:55]
    ds_write_b128 v232, v[40:43] offset:2048
    v_mfma_f32_16x16x32_bf16 v[56:59], v[132:135], v[84:87], v[56:59]
    ds_write_b128 v232, v[44:47] offset:3072
    ds_write_b32 v239, v238 offset:62048
    v_mfma_f32_16x16x32_bf16 v[60:63], v[132:135], v[88:91], v[60:63]
    v_mfma_f32_16x16x32_bf16 v[48:51], v[136:139], v[72:75], v[48:51]
    v_mfma_f32_16x16x32_bf16 v[52:55], v[136:139], v[76:79], v[52:55]
    v_mfma_f32_16x16x32_bf16 v[56:59], v[136:139], v[80:83], v[56:59]
    v_mfma_f32_16x16x32_bf16 v[60:63], v[136:139], v[84:87], v[60:63]
    v_mfma_f32_16x16x32_bf16 v[48:51], v[140:143], v[68:71], v[48:51]
    v_mfma_f32_16x16x32_bf16 v[52:55], v[140:143], v[72:75], v[52:55]
    v_mfma_f32_16x16x32_bf16 v[56:59], v[140:143], v[76:79], v[56:59]
    v_mfma_f32_16x16x32_bf16 v[60:63], v[140:143], v[80:83], v[60:63]
    v_mfma_f32_16x16x32_bf16 v[48:51], v[148:151], v[112:115], v[48:51]
    v_mfma_f32_16x16x32_bf16 v[48:51], v[152:155], v[108:111], v[48:51]
    v_mfma_f32_16x16x32_bf16 v[48:51], v[156:159], v[104:107], v[48:51]
    v_mfma_f32_16x16x32_bf16 v[48:51], v[160:163], v[100:103], v[48:51]
    v_mfma_f32_16x16x32_bf16 v[52:55], v[148:151], v[116:119], v[52:55]
    ds_read_b32 v234, v235 offset:62016
    ds_read_b128 v[168:171], v233 offset:0
    ds_read_b128 v[172:175], v233 offset:1024
    ds_read_b128 v[176:179], v233 offset:2048
    ds_read_b128 v[180:183], v233 offset:3072
    ds_read_b128 v[208:211], v238
    ds_read_b128 v[212:215], v238 offset:2048
    v_mfma_f32_16x16x32_bf16 v[52:55], v[152:155], v[112:115], v[52:55]
    v_mfma_f32_16x16x32_bf16 v[52:55], v[156:159], v[108:111], v[52:55]
    s_waitcnt lgkmcnt(6)
    v_cmp_eq_u32 vcc, 0, v234
    s_and_b32 s44, vcc_lo, s55
    s_cbranch_scc1 L_retry1
L_back1:
    v_readfirstlane_b32 s49, v234

    s_waitcnt lgkmcnt(5)
    v_pk_add_f32 v[48:49], v[48:49], v[168:169]
    v_pk_add_f32 v[50:51], v[50:51], v[170:171]
    v_cvt_pk_bf16_f32 v200, v48, v49
    v_cvt_pk_bf16_f32 v201, v50, v51

    v_mfma_f32_16x16x32_bf16 v[52:55], v[160:163], v[104:107], v[52:55]
    v_mfma_f32_16x16x32_bf16 v[56:59], v[148:151], v[120:123], v[56:59]
    v_mfma_f32_16x16x32_bf16 v[56:59], v[152:155], v[116:119], v[56:59]
    v_mfma_f32_16x16x32_bf16 v[56:59], v[156:159], v[112:115], v[56:59]
    s_waitcnt lgkmcnt(0)
    v_pk_add_f32 v[52:53], v[52:53], v[172:173]
    v_pk_add_f32 v[54:55], v[54:55], v[174:175]
    v_cvt_pk_bf16_f32 v202, v52, v53
    v_cvt_pk_bf16_f32 v203, v54, v55

    s_nop 0
    s_cmp_lg_u32 s49, 0
    v_permlane16_swap_b32 v200, v202
    v_permlane16_swap_b32 v201, v203

    v_xnor_b32 v200, v200, v208
    v_xnor_b32 v202, v202, v210
    v_xnor_b32 v201, v201, v209
    v_xnor_b32 v203, v203, v211
    s_cbranch_scc1 L_sl1_0
    buffer_store_dwordx4 v[200:203], v15, s[12:15], s47 offen
L_bk1_0:

    v_mfma_f32_16x16x32_bf16 v[56:59], v[160:163], v[108:111], v[56:59]
    v_mfma_f32_16x16x32_bf16 v[60:63], v[148:151], v[124:127], v[60:63]
    v_mfma_f32_16x16x32_bf16 v[60:63], v[152:155], v[120:123], v[60:63]
    v_mfma_f32_16x16x32_bf16 v[60:63], v[156:159], v[116:119], v[60:63]
    v_pk_add_f32 v[56:57], v[56:57], v[176:177]
    v_pk_add_f32 v[58:59], v[58:59], v[178:179]
    v_cvt_pk_bf16_f32 v204, v56, v57
    v_cvt_pk_bf16_f32 v205, v58, v59

    v_mfma_f32_16x16x32_bf16 v[60:63], v[160:163], v[112:115], v[60:63]
    s_nop 7
    v_pk_add_f32 v[60:61], v[60:61], v[180:181]
    v_pk_add_f32 v[62:63], v[62:63], v[182:183]
    v_cvt_pk_bf16_f32 v206, v60, v61
    v_cvt_pk_bf16_f32 v207, v62, v63

    s_nop 0
    s_cmp_lg_u32 s49, 0
    v_permlane16_swap_b32 v204, v206
    v_permlane16_swap_b32 v205, v207

    v_xnor_b32 v204, v204, v212
    v_xnor_b32 v206, v206, v214
    v_xnor_b32 v205, v205, v213
    v_xnor_b32 v207, v207, v215
    s_cbranch_scc1 L_sl1_1
    buffer_store_dwordx4 v[204:207], v15, s[12:15], s48 offen
L_bk1_1:

    s_barrier
    s_endpgm
L_retry1:

    ds_read_b32 v234, v235 offset:62016
    ds_read_b128 v[168:171], v233 offset:0
    ds_read_b128 v[172:175], v233 offset:1024
    ds_read_b128 v[176:179], v233 offset:2048
    ds_read_b128 v[180:183], v233 offset:3072
    ds_read_b128 v[208:211], v238
    ds_read_b128 v[212:215], v238 offset:2048
    s_waitcnt lgkmcnt(0)
    v_cmp_eq_u32 vcc, 0, v234
    s_and_b32 s44, vcc_lo, s55
    s_cbranch_scc1 L_retry1
    s_branch L_back1
L_sl1_0:
    s_add_u32 s12, s20, 4194304
    s_addc_u32 s13, s21, 0
    buffer_store_dwordx4 v[200:203], v15, s[12:15], s47 offen sc0 sc1
    s_branch L_bk1_0
L_sl1_1:

    buffer_store_dwordx4 v[204:207], v15, s[12:15], s48 offen sc0 sc1
    s_load_dwordx2 s[36:37], s[16:17], 4088
    s_waitcnt lgkmcnt(0)
    s_add_u32 s36, s36, 16
    s_or_b32 s45, s36, 15
    v_mov_b32 v24, s45
    v_mov_b32 v25, s37
    v_mov_b32 v26, 0
    s_barrier
    s_mov_b64 exec, 1
    s_waitcnt vmcnt(0)
    buffer_store_dwordx2 v[24:25], v26, s[16:19], s39 offen offset:2048 sc0 sc1
    s_endpgm

L_helper:
    v_lshrrev_b32 v4, 3, v3
    v_and_b32 v5, 7, v3
    v_lshlrev_b32 v59, 4, v3

    s_mov_b32 s8, s12
    s_mov_b32 s9, s13
    s_mul_i32 s44, s26, 2560
    s_add_u32 s44, s44, 80960
    v_mul_u32_u24 v28, 576, v97
    v_lshl_add_u32 v28, v96, 3, v28
    v_add_u32 v28, s44, v28
    v_mul_u32_u24 v31, 144, v4
    v_lshl_add_u32 v31, v5, 4, v31
    v_add_u32 v31, s44, v31
    v_lshrrev_b32 v29, 5, v3
    v_lshlrev_b32 v29, 14, v29
    v_and_b32 v30, 7, v96
    v_lshl_add_u32 v29, v30, 10, v29
    v_lshl_add_u32 v29, v97, 4, v29
    s_lshl_b32 s41, s27, 13
    s_lshl_b32 s42, s33, 6
    s_add_u32 s41, s41, s42
    s_add_u32 s41, s41, s30
    s_add_u32 s42, s41, 32768
    v_and_b32 v40, 0xff, v0
    v_lshrrev_b32 v41, 7, v40
    v_mul_u32_u24 v41, 4608, v41
    v_and_b32 v42, 127, v40
    v_lshl_add_u32 v41, v42, 2, v41
    v_mov_b32 v24, 0
    v_mov_b32 v25, 0
    v_mov_b32 v26, 0
    v_mov_b32 v27, 0
    v_lshlrev_b32 v42, 4, v40
    ds_write_b32 v41, v24 offset:62272
    v_and_b32 v43, 60, v40
    ds_write_b32 v43, v24 offset:62016
    v_add_u32 v42, 71488, v42
    v_cmp_gt_u32 vcc, 80, v40
    ds_write_b128 v42, v[24:27]
    ds_write_b128 v42, v[24:27] offset:4096
    s_and_saveexec_b64 s[44:45], vcc
    ds_write_b128 v42, v[24:27] offset:8192
    s_mov_b64 exec, -1
    v_lshrrev_b32 v58, 1, v4
    v_lshlrev_b32 v58, 16, v58
    v_and_b32 v30, 1, v4
    v_lshl_add_u32 v58, v30, 10, v58
    v_lshrrev_b32 v30, 2, v5
    v_lshl_add_u32 v58, v30, 13, v58
    v_lshl_add_u32 v58, v97, 4, v58
    s_lshl_b32 s47, s26, 19
    s_add_u32 s46, s58, s47
    s_add_u32 s47, s46, 0x40000
    s_lshl_b32 s54, s33, 9
    s_lshl_b32 s44, s29, 4
    s_add_u32 s54, s54, s44
    s_lshl_b32 s44, s27, 3
    s_add_u32 s54, s54, s44
    s_lshr_b32 s44, s29, 4
    s_lshl_b32 s44, s44, 9
    s_lshl_b32 s45, s26, 7
    s_add_u32 s44, s44, s45
    v_and_b32 v98, 15, v3
    v_lshl_add_u32 v98, v98, 3, s44
    s_lshl_b32 s56, s26, 11
    s_add_u32 s56, s56, 91200
    v_add_u32 v53, s56, v59
    s_lshl_b32 s56, s26, 2
    v_mov_b32 v52, s56
    v_and_b32 v146, 60, v3
    s_mul_i32 s56, s26, 2176
    s_add_u32 s56, s56, 16384
    v_lshrrev_b32 v144, 5, v3
    v_mul_u32_u24 v144, 544, v144
    v_and_b32 v145, 31, v3
    v_lshl_add_u32 v144, v145, 4, v144
    v_add_u32 v144, s56, v144
    v_mul_u32_u24 v145, 544, v97
    v_lshl_add_u32 v145, v96, 2, v145
    v_add_u32 v145, s56, v145
    s_mov_b32 s44, 0x05040100
    s_mov_b32 s45, 0x07060302
    s_lshl_b32 s43, s26, 10
    s_add_u32 s43, s43, 62784
    v_lshlrev_b32 v56, 6, v4
    v_and_b32 v57, 2, v3
    v_lshl_add_u32 v56, v57, 4, v56
    v_and_b32 v57, 4, v3
    v_lshl_add_u32 v56, v57, 2, v56
    v_and_b32 v57, 1, v3
    v_lshl_add_u32 v56, v57, 3, v56
    v_add_u32 v56, s43, v56

    s_waitcnt vmcnt(6)
    ds_write2_b32 v28, v8, v12 offset0:0 offset1:1
    ds_write2_b32 v28, v9, v13 offset0:36 offset1:37
    ds_write2_b32 v28, v10, v14 offset0:72 offset1:73
    ds_write2_b32 v28, v11, v15 offset0:108 offset1:109
    s_waitcnt lgkmcnt(0)
    ds_read_b128 v[32:35], v31
    ds_read_b128 v[36:39], v31 offset:1152
    s_waitcnt lgkmcnt(1)
    buffer_store_dwordx4 v[32:35], v29, s[12:15], s41 offen
    s_waitcnt lgkmcnt(0)
    buffer_store_dwordx4 v[36:39], v29, s[12:15], s42 offen
    s_waitcnt vmcnt(5)

    v_mul_f32 v24, s50, v20
    v_mul_f32 v25, s51, v20
    v_exp_f32 v24, v24
    v_mul_f32 v26, s50, v16
    v_mul_f32 v27, s51, v16
    v_fma_f32 v24, v24, v25, v24
    v_exp_f32 v26, v26
    v_cvt_pk_bf16_f32 v24, v24, v24
    v_mov_b32 v120, 0x3f80
    v_fma_f32 v26, v26, v27, v26
    v_lshlrev_b32 v20, 16, v24
    v_cvt_pk_bf16_f32 v26, v26, v26
    v_mul_f32 v22, v17, v20
    v_lshlrev_b32 v21, 16, v26
    v_mul_f32 v22, 0x3e22f983, v22
    v_mul_f32 v21, v21, v20
    v_mul_f32 v51, 0x41000000, v22
    v_mul_f32 v21, 0xbfb8aa3b, v21
    v_fract_f32 v51, v51
    v_mul_f32 v50, 0x41000000, v21
    v_cos_f32 v64, v51
    v_exp_f32 v50, v50
    v_sin_f32 v65, v51
    ds_write_addtid_b32 v120 offset:22304
    v_pk_mul_f32 v[64:65], v[64:65], v[50:51] op_sel_hi:[1,0]
    v_pk_mul_f32 v[112:113], v[64:65], v[64:65] op_sel_hi:[1,0]
    v_cvt_pk_bf16_f32 v122, v64, v65
    v_pk_fma_f32 v[66:67], v[64:65], v[64:65], v[112:113] op_sel:[1,1,0] op_sel_hi:[0,1,1] neg_lo:[0,1,0]
    ds_write_addtid_b32 v122 offset:22848
    v_pk_mul_f32 v[114:115], v[66:67], v[64:65] op_sel_hi:[1,0]
    v_pk_mul_f32 v[116:117], v[66:67], v[66:67] op_sel_hi:[1,0]
    v_pk_fma_f32 v[68:69], v[66:67], v[64:65], v[114:115] op_sel:[1,1,0] op_sel_hi:[0,1,1] neg_lo:[0,1,0]
    v_pk_fma_f32 v[70:71], v[66:67], v[66:67], v[116:117] op_sel:[1,1,0] op_sel_hi:[0,1,1] neg_lo:[0,1,0]
    v_cvt_pk_bf16_f32 v123, v66, v67
    v_pk_mul_f32 v[110:111], v[64:65], v[70:71] op_sel_hi:[1,0]
    v_pk_mul_f32 v[112:113], v[66:67], v[70:71] op_sel_hi:[1,0]
    v_pk_mul_f32 v[114:115], v[68:69], v[70:71] op_sel_hi:[1,0]
    v_pk_fma_f32 v[72:73], v[64:65], v[70:71], v[110:111] op_sel:[1,1,0] op_sel_hi:[0,1,1] neg_lo:[0,1,0]
    v_pk_fma_f32 v[74:75], v[66:67], v[70:71], v[112:113] op_sel:[1,1,0] op_sel_hi:[0,1,1] neg_lo:[0,1,0]
    v_pk_fma_f32 v[76:77], v[68:69], v[70:71], v[114:115] op_sel:[1,1,0] op_sel_hi:[0,1,1] neg_lo:[0,1,0]
    v_pk_mul_f32 v[116:117], v[70:71], v[70:71] op_sel_hi:[1,0]
    v_pk_mul_f32 v[110:111], v[72:73], v[70:71] op_sel_hi:[1,0]
    v_pk_mul_f32 v[112:113], v[74:75], v[70:71] op_sel_hi:[1,0]
    v_pk_mul_f32 v[114:115], v[76:77], v[70:71] op_sel_hi:[1,0]
    v_cvt_pk_bf16_f32 v124, v68, v69
    v_pk_fma_f32 v[78:79], v[70:71], v[70:71], v[116:117] op_sel:[1,1,0] op_sel_hi:[0,1,1] neg_lo:[0,1,0]
    v_pk_fma_f32 v[80:81], v[72:73], v[70:71], v[110:111] op_sel:[1,1,0] op_sel_hi:[0,1,1] neg_lo:[0,1,0]
    v_pk_fma_f32 v[82:83], v[74:75], v[70:71], v[112:113] op_sel:[1,1,0] op_sel_hi:[0,1,1] neg_lo:[0,1,0]
    v_pk_fma_f32 v[84:85], v[76:77], v[70:71], v[114:115] op_sel:[1,1,0] op_sel_hi:[0,1,1] neg_lo:[0,1,0]
    ds_write_addtid_b32 v123 offset:23392
    ds_write_addtid_b32 v124 offset:23936
    v_pk_mul_f32 v[116:117], v[78:79], v[70:71] op_sel_hi:[1,0]
    v_pk_mul_f32 v[110:111], v[80:81], v[70:71] op_sel_hi:[1,0]
    v_pk_mul_f32 v[112:113], v[82:83], v[70:71] op_sel_hi:[1,0]
    v_pk_mul_f32 v[114:115], v[84:85], v[70:71] op_sel_hi:[1,0]
    v_cvt_pk_bf16_f32 v125, v70, v71
    v_cvt_pk_bf16_f32 v126, v72, v73
    v_cvt_pk_bf16_f32 v121, v74, v75
    v_cvt_pk_bf16_f32 v122, v76, v77
    v_cvt_pk_bf16_f32 v123, v78, v79
    v_cvt_pk_bf16_f32 v124, v80, v81
    v_pk_fma_f32 v[86:87], v[78:79], v[70:71], v[116:117] op_sel:[1,1,0] op_sel_hi:[0,1,1] neg_lo:[0,1,0]
    v_pk_fma_f32 v[88:89], v[80:81], v[70:71], v[110:111] op_sel:[1,1,0] op_sel_hi:[0,1,1] neg_lo:[0,1,0]
    v_pk_fma_f32 v[90:91], v[82:83], v[70:71], v[112:113] op_sel:[1,1,0] op_sel_hi:[0,1,1] neg_lo:[0,1,0]
    v_pk_fma_f32 v[92:93], v[84:85], v[70:71], v[114:115] op_sel:[1,1,0] op_sel_hi:[0,1,1] neg_lo:[0,1,0]
    ds_write_addtid_b32 v125 offset:24480
    ds_write_addtid_b32 v126 offset:25024
    ds_write_addtid_b32 v121 offset:25568
    ds_write_addtid_b32 v122 offset:26112
    ds_write_addtid_b32 v123 offset:26656
    ds_write_addtid_b32 v124 offset:27200
    v_cvt_pk_bf16_f32 v125, v82, v83
    v_cvt_pk_bf16_f32 v126, v84, v85
    v_cvt_pk_bf16_f32 v121, v86, v87
    v_cvt_pk_bf16_f32 v122, v88, v89
    v_cvt_pk_bf16_f32 v123, v90, v91
    v_cvt_pk_bf16_f32 v124, v92, v93
    ds_write_addtid_b32 v125 offset:27744
    ds_write_addtid_b32 v126 offset:28288
    ds_write_addtid_b32 v121 offset:28832
    ds_write_addtid_b32 v122 offset:29376
    ds_write_addtid_b32 v123 offset:29920
    ds_write_addtid_b32 v124 offset:30464
    v_mov_b32 v26, 0
    s_waitcnt vmcnt(2)
    v_readfirstlane_b32 s36, v54
    v_readfirstlane_b32 s37, v55
    s_mov_b32 s62, 0
    s_add_u32 s36, s36, 16
    s_and_b32 s36, s36, -16
    s_or_b32 s52, s36, s25
    s_mov_b32 s53, s37
    v_mov_b32 v54, s52
    s_mov_b64 exec, 1
    s_waitcnt lgkmcnt(0)

    s_waitcnt vmcnt(0)
    buffer_store_dwordx2 v[54:55], v26, s[16:19], s54 offen
    s_mov_b64 exec, -1

    s_barrier
L_poll0:
    buffer_load_dwordx2 v[112:113], v98, s[16:19], 0 offen sc1
    buffer_load_dwordx2 v[114:115], v98, s[16:19], 0 offen sc1
    buffer_load_dwordx2 v[116:117], v98, s[16:19], 0 offen sc1
L_poll1:
    buffer_load_dwordx2 v[118:119], v98, s[16:19], 0 offen sc1
    s_waitcnt vmcnt(3)
    v_cmp_ne_u64 vcc, s[52:53], v[112:113]
    s_cbranch_vccz L_ok1

    buffer_load_dwordx2 v[112:113], v98, s[16:19], 0 offen sc1
    s_waitcnt vmcnt(3)
    v_cmp_ne_u64 vcc, s[52:53], v[114:115]
    s_cbranch_vccz L_ok1

    buffer_load_dwordx2 v[114:115], v98, s[16:19], 0 offen sc1
    s_waitcnt vmcnt(3)
    v_cmp_ne_u64 vcc, s[52:53], v[116:117]
    s_cbranch_vccz L_ok1

    buffer_load_dwordx2 v[116:117], v98, s[16:19], 0 offen sc1
    s_waitcnt vmcnt(3)
    v_cmp_ne_u64 vcc, s[52:53], v[118:119]
    s_cbranch_vccz L_ok1

    s_add_u32 s62, s62, 1
    s_cmp_lt_u32 s62, 96
    s_cbranch_scc1 L_poll1
    s_branch L_slow1
L_ok1:

    buffer_load_dwordx4 v[40:43], v58, s[8:11], s46 offen sc1
    buffer_load_dwordx4 v[44:47], v58, s[8:11], s47 offen sc1

    v_lshlrev_b32 v80, 16, v60
    v_and_b32 v81, 0xffff0000, v60
    v_lshlrev_b32 v82, 16, v61
    v_and_b32 v83, 0xffff0000, v61
    v_lshlrev_b32 v84, 16, v62
    v_and_b32 v85, 0xffff0000, v62
    v_lshlrev_b32 v86, 16, v63
    v_and_b32 v87, 0xffff0000, v63
    v_lshlrev_b32 v64, 16, v8
    v_and_b32 v65, 0xffff0000, v8
    v_pk_mul_f32 v[64:65], v[64:65], v[80:81]
    v_cvt_pk_bf16_f32 v65, v64, v65
    v_lshlrev_b32 v64, 16, v65
    v_and_b32 v65, 0xffff0000, v65

    v_lshlrev_b32 v66, 16, v9
    v_and_b32 v67, 0xffff0000, v9
    v_pk_mul_f32 v[66:67], v[66:67], v[82:83]
    v_cvt_pk_bf16_f32 v67, v66, v67
    v_lshlrev_b32 v66, 16, v67
    v_and_b32 v67, 0xffff0000, v67

    v_lshlrev_b32 v68, 16, v10
    v_and_b32 v69, 0xffff0000, v10
    v_pk_mul_f32 v[68:69], v[68:69], v[84:85]
    v_cvt_pk_bf16_f32 v69, v68, v69
    v_lshlrev_b32 v68, 16, v69
    v_and_b32 v69, 0xffff0000, v69

    v_lshlrev_b32 v70, 16, v11
    v_and_b32 v71, 0xffff0000, v11
    v_pk_mul_f32 v[70:71], v[70:71], v[86:87]
    v_cvt_pk_bf16_f32 v71, v70, v71
    v_lshlrev_b32 v70, 16, v71
    v_and_b32 v71, 0xffff0000, v71

    v_lshlrev_b32 v72, 16, v12
    v_and_b32 v73, 0xffff0000, v12
    v_pk_mul_f32 v[72:73], v[72:73], v[80:81]
    v_cvt_pk_bf16_f32 v73, v72, v73
    v_lshlrev_b32 v72, 16, v73
    v_and_b32 v73, 0xffff0000, v73

    v_lshlrev_b32 v74, 16, v13
    v_and_b32 v75, 0xffff0000, v13
    v_pk_mul_f32 v[74:75], v[74:75], v[82:83]
    v_cvt_pk_bf16_f32 v75, v74, v75
    v_lshlrev_b32 v74, 16, v75
    v_and_b32 v75, 0xffff0000, v75

    v_lshlrev_b32 v76, 16, v14
    v_and_b32 v77, 0xffff0000, v14
    v_pk_mul_f32 v[76:77], v[76:77], v[84:85]
    v_cvt_pk_bf16_f32 v77, v76, v77
    v_lshlrev_b32 v76, 16, v77
    v_and_b32 v77, 0xffff0000, v77

    v_lshlrev_b32 v78, 16, v15
    v_and_b32 v79, 0xffff0000, v15
    v_pk_mul_f32 v[78:79], v[78:79], v[86:87]
    v_cvt_pk_bf16_f32 v79, v78, v79
    v_lshlrev_b32 v78, 16, v79
    v_and_b32 v79, 0xffff0000, v79

    s_waitcnt vmcnt(1)
    v_perm_b32 v48, v41, v40, s44
    v_perm_b32 v49, v43, v42, s44
    v_perm_b32 v50, v41, v40, s45
    v_perm_b32 v51, v43, v42, s45
    ds_write_b64 v56, v[48:49] offset:0
    ds_write_b64 v56, v[50:51] offset:4608

    s_waitcnt vmcnt(0)
    v_perm_b32 v48, v45, v44, s44
    v_perm_b32 v49, v47, v46, s44
    v_perm_b32 v50, v45, v44, s45
    v_perm_b32 v51, v47, v46, s45
    ds_write_b64 v56, v[48:49] offset:512
    ds_write_b64 v56, v[50:51] offset:5120

    s_waitcnt lgkmcnt(0)
    s_barrier
    s_setprio 0

    s_mov_b32 s8, s12
    s_mov_b32 s9, s13
    s_mov_b32 s63, 0
    ds_write_b128 v53, v[40:43]
    ds_write_b128 v53, v[44:47] offset:1024
    ds_write_b32 v52, v53 offset:62064
L_md:
    ds_read_b32 v52, v146 offset:62016
    s_waitcnt lgkmcnt(0)
    v_cmp_eq_u32 vcc, 0, v52
    s_and_b32 s44, vcc_hi, 0x11110000
    s_cbranch_scc1 L_md
    v_readfirstlane_b32 s49, v52
    s_setprio 2
    s_nop 2
    s_cmp_lg_u32 s49, 0
    s_barrier
    s_cbranch_scc1 L_slow2
L_poll2:
    buffer_load_dwordx4 v[40:43], v29, s[8:11], s41 offen sc1
    buffer_load_dwordx4 v[44:47], v29, s[8:11], s42 offen sc1
    s_add_u32 s63, s63, 1
    s_cmp_ge_u32 s63, 100000
    s_waitcnt vmcnt(1)
    v_xnor_b32 v40, v40, v32
    v_xnor_b32 v41, v41, v33
    v_xnor_b32 v42, v42, v34
    v_xnor_b32 v43, v43, v35
    v_max3_u32 v48, v40, v41, v42
    ds_write_b128 v144, v[40:43]
    s_waitcnt vmcnt(0)
    v_xnor_b32 v44, v44, v36
    v_xnor_b32 v45, v45, v37
    v_xnor_b32 v46, v46, v38
    v_xnor_b32 v47, v47, v39
    v_max3_u32 v48, v48, v43, v44
    ds_write_b128 v144, v[44:47] offset:1088
    v_max3_u32 v49, v45, v46, v47
    v_max_u32 v48, v48, v49
    v_cmp_eq_u32 vcc, -1, v48
    s_cbranch_scc1 L_ok2
    s_cbranch_vccnz L_poll2w
L_ok2:

    ds_read2_b32 v[100:101], v145 offset0:0 offset1:16
    ds_read2_b32 v[102:103], v145 offset0:32 offset1:48
    ds_read2_b32 v[104:105], v145 offset0:64 offset1:80
    ds_read2_b32 v[106:107], v145 offset0:96 offset1:112
    s_waitcnt lgkmcnt(3)
    v_lshlrev_b32 v80, 16, v100
    v_lshlrev_b32 v81, 16, v101
    v_and_b32 v82, 0xffff0000, v100
    v_and_b32 v83, 0xffff0000, v101
    v_pk_add_f32 v[80:81], v[80:81], v[64:65]
    v_pk_add_f32 v[82:83], v[82:83], v[72:73]
    v_cvt_pk_bf16_f32 v48, v80, v81
    v_cvt_pk_bf16_f32 v52, v82, v83

    s_waitcnt lgkmcnt(2)
    v_lshlrev_b32 v84, 16, v102
    v_lshlrev_b32 v85, 16, v103
    v_and_b32 v86, 0xffff0000, v102
    v_and_b32 v87, 0xffff0000, v103
    v_pk_add_f32 v[84:85], v[84:85], v[66:67]
    v_pk_add_f32 v[86:87], v[86:87], v[74:75]
    v_cvt_pk_bf16_f32 v49, v84, v85
    v_cvt_pk_bf16_f32 v53, v86, v87

    s_waitcnt lgkmcnt(1)
    v_lshlrev_b32 v88, 16, v104
    v_lshlrev_b32 v89, 16, v105
    v_and_b32 v90, 0xffff0000, v104
    v_and_b32 v91, 0xffff0000, v105
    v_pk_add_f32 v[88:89], v[88:89], v[68:69]
    v_pk_add_f32 v[90:91], v[90:91], v[76:77]
    v_cvt_pk_bf16_f32 v50, v88, v89
    v_cvt_pk_bf16_f32 v54, v90, v91

    s_waitcnt lgkmcnt(0)
    v_lshlrev_b32 v92, 16, v106
    v_lshlrev_b32 v93, 16, v107
    v_and_b32 v94, 0xffff0000, v106
    v_and_b32 v95, 0xffff0000, v107
    v_pk_add_f32 v[92:93], v[92:93], v[70:71]
    v_pk_add_f32 v[94:95], v[94:95], v[78:79]
    v_cvt_pk_bf16_f32 v51, v92, v93
    v_cvt_pk_bf16_f32 v55, v94, v95

    buffer_store_dwordx4 v[48:51], v6, s[12:15], s30 offen
    buffer_store_dwordx4 v[52:55], v6, s[12:15], s30 offen offset:1024
    s_cmp_lg_u32 s39, 0
    s_cbranch_scc1 L_noep
    s_mov_b64 exec, 1
    v_mov_b32 v24, s36
    v_mov_b32 v25, s37
    s_movk_i32 s44, 4088
    buffer_store_dwordx2 v[24:25], v26, s[16:19], s44 offen
L_noep:

    s_endpgm
L_poll2w:
    s_waitcnt lgkmcnt(0)
    s_branch L_poll2
L_slow1:
    s_waitcnt vmcnt(0)
    s_cmp_lg_u32 s62, 96
    s_cbranch_scc1 L_slow1b
    v_and_b32 v106, 1, v3
    v_lshlrev_b32 v106, 3, v106
    v_and_b32 v107, 2, v3
    v_lshl_add_u32 v106, v107, 8, v106
    s_lshl_b32 s56, s29, 4
    s_mov_b32 s57, 0
L_slow1a:
    buffer_load_dwordx2 v[108:109], v106, s[16:19], s56 offen sc1
    s_add_u32 s57, s57, 1
    s_cmp_ge_u32 s57, 100000
    s_waitcnt vmcnt(0)
    v_cmp_ne_u64 vcc, s[52:53], v[108:109]
    s_cbranch_scc1 L_slow1d
    s_cbranch_vccnz L_slow1a
L_slow1d:
    s_add_u32 s4, s20, 8388608
    s_addc_u32 s5, s21, 0
    s_mov_b32 s6, 0x200000
    s_mov_b32 s7, 0x20000
    v_lshlrev_b32 v106, 10, v4
    v_lshl_add_u32 v106, v5, 4, v106
    s_mov_b32 s56, s30
    s_add_u32 s57, s30, 65536
L_slow1e:
    buffer_load_dwordx4 v[108:111], v106, s[12:15], s56 offen sc1
    s_waitcnt vmcnt(0)
    buffer_store_dwordx4 v[108:111], v106, s[4:7], s56 offen sc0 sc1
    s_waitcnt vmcnt(0)
    s_add_u32 s56, s56, 8192
    s_cmp_lt_u32 s56, s57
    s_cbranch_scc1 L_slow1e
    s_lshl_b32 s56, s29, 3
    s_mov_b64 exec, 1
    buffer_store_dwordx2 v[54:55], v26, s[16:19], s56 offen offset:1024 sc0 sc1
    s_mov_b64 exec, -1
L_slow1b:
    v_and_b32 v106, 31, v3
    v_lshlrev_b32 v106, 3, v106
    buffer_load_dwordx2 v[108:109], v106, s[16:19], 0 offen offset:1024 sc1
    s_waitcnt vmcnt(0)
    v_cmp_ne_u64 s[56:57], s[52:53], v[108:109]
    v_and_b32 v108, -16, v108
    v_cmp_ne_u64 vcc, s[36:37], v[108:109]
    s_cbranch_vccnz L_slow1c
    s_cmp_lg_u64 s[56:57], 0
    s_cbranch_scc0 L_ok1
    v_mov_b32 v108, 1
    ds_write_b32 v26, v108 offset:62016
    s_add_u32 s8, s20, 8388608
    s_addc_u32 s9, s21, 0
    s_branch L_ok1
L_slow1c:
    s_cmp_lt_u32 s62, 50000
    s_cbranch_scc1 L_poll0
    s_branch L_ok1
L_slow2:
    s_add_u32 s8, s20, 4194304
    s_addc_u32 s9, s21, 0
    s_or_b32 s52, s36, 15
L_slow2b:
    buffer_load_dwordx4 v[40:43], v59, s[16:19], 0 offen offset:2048 sc1
    s_add_u32 s63, s63, 1
    s_waitcnt vmcnt(0)
    v_cmp_ne_u64 vcc, s[52:53], v[40:41]
    v_cmp_ne_u64 s[44:45], s[52:53], v[42:43]
    s_or_b64 vcc, vcc, s[44:45]
    s_cbranch_vccz L_slow2c
    s_cmp_lt_u32 s63, 100000
    s_cbranch_scc1 L_slow2b
L_slow2c:
    s_mov_b32 s63, 100000
    s_branch L_poll2
L_end:

s_endpgm
.section .rodata,"a"
.p2align 6
.amdhsa_kernel standalone__ssm_conv_s4d__prompt_kernel
  .amdhsa_next_free_vgpr 240
  .amdhsa_next_free_sgpr 102
  .amdhsa_accum_offset 240
  .amdhsa_group_segment_fixed_size 0
  .amdhsa_kernarg_size 80
  .amdhsa_user_sgpr_count 2
  .amdhsa_user_sgpr_kernarg_segment_ptr 1
  .amdhsa_system_sgpr_workgroup_id_x 1
.end_amdhsa_kernel
```
